```python
import torch

def _softmax(x, axis=-1):
    return torch.softmax(x, dim=axis)
def _gelu(x):
    return torch.nn.functional.gelu(x, approximate="tanh")
def _silu(x):
    return torch.nn.functional.silu(x)
def _sigmoid(x):
    return torch.sigmoid(x)
def _layernorm(x, axis=-1, eps=1e-5):
    m = x.mean(dim=axis, keepdim=True)
    v = x.var(dim=axis, keepdim=True, unbiased=False)
    return (x - m) / torch.sqrt(v + eps)
def _scatter_add(tgt, idx, src, axis=0):
    return tgt.clone().index_add_(axis, idx, src)
def _segment_sum(src, seg, n):
    out = torch.zeros((n,) + src.shape[1:], dtype=src.dtype)
    return out.index_add_(0, seg, src)
def _pad(x, pw):
    flat = tuple(v for pair in reversed(pw) for v in pair)
    return torch.nn.functional.pad(x, flat)

kernel_name = 'sequential_preLN__gqa_block_cached__dense_activation_squared_relu__decode'

def setup_inputs():

    _w = (lambda a: (lambda t: t.to(torch.bfloat16) if t.is_floating_point() else t)(torch.as_tensor(a)))
    def _A_setup():
        B, Sq, D = 1, 1, 512
        Hq, Hkv, Sk, Dh = 32, 8, 65536, 128
        assert Hq % Hkv == 0, (Hq, Hkv)
        return {
            "x": _w((lambda *s: torch.randn(*s, dtype=torch.bfloat16) * 0.05)(B, Sq, D)),
            "k_cache": _w((lambda *s: torch.randn(*s, dtype=torch.bfloat16) * 3.2)(B, Hkv, Sk, Dh)),
            "v_cache": _w((lambda *s: torch.randn(*s, dtype=torch.bfloat16) * 0.4)(B, Hkv, Sk, Dh)),
            "wq": _w((lambda *s: torch.randn(*s, dtype=torch.bfloat16) * 3.2)(D, Hq * Dh) * (D ** -0.5)),
            "wo": _w((lambda *s: torch.randn(*s, dtype=torch.bfloat16) * 0.4)(Hq * Dh, D) * ((Hq * Dh) ** -0.5)),
        }
    _A_in = _A_setup()

    def _B_setup():
        B, S, D, F = 1, 1, 512, 1792
        return {
            "x": _w((lambda *s: torch.randn(*s, dtype=torch.bfloat16) * 0.05)(B, S, D)),
            "w1": _w((lambda *s: torch.randn(*s, dtype=torch.bfloat16) * 0.05)(D, F)),
            "b1": _w((lambda *s: torch.randn(*s, dtype=torch.bfloat16) * 0.8)(F)),
            "w2": _w((lambda *s: torch.randn(*s, dtype=torch.bfloat16) * 0.05)(F, D)),
            "b2": _w((lambda *s: torch.randn(*s, dtype=torch.bfloat16) * 3.2)(D)),
        }
    _B_in = _B_setup()

    return {
        "A_x": _A_in["x"],
        "A_k_cache": _A_in["k_cache"],
        "A_v_cache": _A_in["v_cache"],
        "A_wq": _A_in["wq"],
        "A_wo": _A_in["wo"],
        "B_x": _B_in["x"],
        "B_w1": _B_in["w1"],
        "B_b1": _B_in["b1"],
        "B_w2": _B_in["w2"],
        "B_b2": _B_in["b2"],
    }

def reference(A_x, A_k_cache, A_v_cache, A_wq, A_wo, B_x, B_w1, B_b1, B_w2, B_b2):
    def _A_ref(x, k_cache, v_cache, wq, wo):
        B, Sq, D = x.shape
        Hq, Dh = 32, 128
        Hkv = k_cache.shape[1]
        rep = Hq // Hkv
        q = (lambda x, *d: x.permute(*d))((x @ wq).reshape(B, Sq, Hq, Dh), 0, 2, 1, 3)
        k = (lambda x, n, axis: torch.repeat_interleave(x, n, dim=axis))(k_cache, rep, axis=1)
        v = (lambda x, n, axis: torch.repeat_interleave(x, n, dim=axis))(v_cache, rep, axis=1)
        scores = torch.einsum("bhqd,bhkd->bhqk", q, k) * (Dh ** -0.5)
        p = _softmax(scores, axis=-1)
        o = torch.einsum("bhqk,bhkd->bhqd", p, v)
        return (lambda x, *d: x.permute(*d))(o, 0, 2, 1, 3).reshape(B, Sq, Hq * Dh) @ wo

    def _B_ref(x, w1, b1, w2, b2):
        h = torch.einsum("bsd,df->bsf", x, w1) + b1
        zero = torch.zeros_like(h)
        r = torch.where(h > zero, h, zero)
        h = r * r
        out = torch.einsum("bsf,fd->bsd", h, w2) + b2
        return out

    x = A_x
    h = x + _A_ref(_layernorm(x, axis=-1), A_k_cache, A_v_cache, A_wq, A_wo)
    h2 = h + _B_ref(_layernorm(h, axis=-1), B_w1, B_b1, B_w2, B_b2)
    return h2
```

```asm
; @launch kernel=qproj_kernel grid=(64,1,1) block=(256,1,1) lds=12288
; @launch kernel=attn_kernel grid=(256,1,1) block=(512,1,1) lds=131072
; @launch kernel=oproj_kernel grid=(256,1,1) block=(256,1,1) lds=4096
; @launch kernel=mlp_kernel grid=(56,1,1) block=(256,1,1) lds=68608
.amdgcn_target "amdgcn-amd-amdhsa--gfx950"
.text
.globl qproj_kernel
.p2align 8
.type qproj_kernel,@function
qproj_kernel:
  s_cmp_ge_u32 s2, 64
  s_cbranch_scc1 L_q_end
  s_load_dwordx2 s[4:5], s[0:1], 0
  s_load_dwordx2 s[6:7], s[0:1], 24
  s_load_dwordx2 s[8:9], s[0:1], 96
  v_and_b32 v1, 63, v0
  v_lshrrev_b32 v2, 6, v0
  v_and_b32 v3, 7, v0
  v_lshrrev_b32 v4, 3, v0
  v_lshlrev_b32 v5, 13, v4
  v_lshl_add_u32 v5, v3, 4, v5
  s_lshl_b32 s3, s2, 7
  v_add_u32 v5, s3, v5
  v_lshlrev_b32 v6, 4, v1
  s_waitcnt lgkmcnt(0)
  global_load_dwordx4 v[8:11], v6, s[4:5]
  global_load_dwordx4 v[32:35], v5, s[6:7]
  v_add_u32 v5, 0x40000, v5
  global_load_dwordx4 v[36:39], v5, s[6:7]
  v_add_u32 v5, 0x40000, v5
  global_load_dwordx4 v[40:43], v5, s[6:7]
  v_add_u32 v5, 0x40000, v5
  global_load_dwordx4 v[44:47], v5, s[6:7]
  v_add_u32 v5, 0x40000, v5
  global_load_dwordx4 v[48:51], v5, s[6:7]
  v_add_u32 v5, 0x40000, v5
  global_load_dwordx4 v[52:55], v5, s[6:7]
  v_add_u32 v5, 0x40000, v5
  global_load_dwordx4 v[56:59], v5, s[6:7]
  v_add_u32 v5, 0x40000, v5
  global_load_dwordx4 v[60:63], v5, s[6:7]
  v_add_u32 v5, 0x40000, v5
  global_load_dwordx4 v[64:67], v5, s[6:7]
  v_add_u32 v5, 0x40000, v5
  global_load_dwordx4 v[68:71], v5, s[6:7]
  v_add_u32 v5, 0x40000, v5
  global_load_dwordx4 v[72:75], v5, s[6:7]
  v_add_u32 v5, 0x40000, v5
  global_load_dwordx4 v[76:79], v5, s[6:7]
  v_add_u32 v5, 0x40000, v5
  global_load_dwordx4 v[80:83], v5, s[6:7]
  v_add_u32 v5, 0x40000, v5
  global_load_dwordx4 v[84:87], v5, s[6:7]
  v_add_u32 v5, 0x40000, v5
  global_load_dwordx4 v[88:91], v5, s[6:7]
  v_add_u32 v5, 0x40000, v5
  global_load_dwordx4 v[92:95], v5, s[6:7]
  s_cmp_lg_u32 s2, 0
  s_cbranch_scc1 L_q_nz
  v_mov_b32 v12, 0
  v_mov_b32 v13, 0
  v_mov_b32 v14, 0
  v_mov_b32 v15, 0
  v_lshlrev_b32 v7, 4, v0
  v_add_u32 v7, 8192, v7
  global_store_dwordx4 v7, v[12:15], s[8:9]
L_q_nz:
  s_waitcnt vmcnt(16)
  v_lshlrev_b32 v16, 16, v8
  v_and_b32 v17, 0xffff0000, v8
  v_lshlrev_b32 v18, 16, v9
  v_and_b32 v19, 0xffff0000, v9
  v_lshlrev_b32 v20, 16, v10
  v_and_b32 v21, 0xffff0000, v10
  v_lshlrev_b32 v22, 16, v11
  v_and_b32 v23, 0xffff0000, v11
  v_add_f32 v24, v16, v17
  v_add_f32 v24, v24, v18
  v_add_f32 v24, v24, v19
  v_add_f32 v24, v24, v20
  v_add_f32 v24, v24, v21
  v_add_f32 v24, v24, v22
  v_add_f32 v24, v24, v23
  s_nop 1
  v_mov_b32_dpp v25, v24 quad_perm:[1,0,3,2] row_mask:0xf bank_mask:0xf
  v_add_f32 v24, v24, v25
  s_nop 1
  v_mov_b32_dpp v25, v24 quad_perm:[2,3,0,1] row_mask:0xf bank_mask:0xf
  v_add_f32 v24, v24, v25
  s_nop 1
  v_mov_b32_dpp v25, v24 row_half_mirror row_mask:0xf bank_mask:0xf
  v_add_f32 v24, v24, v25
  s_nop 1
  v_mov_b32_dpp v25, v24 row_mirror row_mask:0xf bank_mask:0xf
  v_add_f32 v24, v24, v25
  v_mov_b32 v25, v24
  s_nop 1
  v_permlane16_swap_b32 v24, v25
  v_add_f32 v24, v24, v25
  v_mov_b32 v25, v24
  s_nop 1
  v_permlane32_swap_b32 v24, v25
  v_add_f32 v24, v24, v25
  v_mul_f32 v24, 0x3b000000, v24
  v_sub_f32 v25, v16, v24
  v_mul_f32 v26, v25, v25
  v_sub_f32 v25, v17, v24
  v_fmac_f32 v26, v25, v25
  v_sub_f32 v25, v18, v24
  v_fmac_f32 v26, v25, v25
  v_sub_f32 v25, v19, v24
  v_fmac_f32 v26, v25, v25
  v_sub_f32 v25, v20, v24
  v_fmac_f32 v26, v25, v25
  v_sub_f32 v25, v21, v24
  v_fmac_f32 v26, v25, v25
  v_sub_f32 v25, v22, v24
  v_fmac_f32 v26, v25, v25
  v_sub_f32 v25, v23, v24
  v_fmac_f32 v26, v25, v25
  s_nop 1
  v_mov_b32_dpp v25, v26 quad_perm:[1,0,3,2] row_mask:0xf bank_mask:0xf
  v_add_f32 v26, v26, v25
  s_nop 1
  v_mov_b32_dpp v25, v26 quad_perm:[2,3,0,1] row_mask:0xf bank_mask:0xf
  v_add_f32 v26, v26, v25
  s_nop 1
  v_mov_b32_dpp v25, v26 row_half_mirror row_mask:0xf bank_mask:0xf
  v_add_f32 v26, v26, v25
  s_nop 1
  v_mov_b32_dpp v25, v26 row_mirror row_mask:0xf bank_mask:0xf
  v_add_f32 v26, v26, v25
  v_mov_b32 v25, v26
  s_nop 1
  v_permlane16_swap_b32 v26, v25
  v_add_f32 v26, v26, v25
  v_mov_b32 v25, v26
  s_nop 1
  v_permlane32_swap_b32 v26, v25
  v_add_f32 v26, v26, v25
  v_mul_f32 v26, 0x3b000000, v26
  v_cvt_pk_bf16_f32 v25, v26, v26
  v_lshlrev_b32 v26, 16, v25
  v_add_f32 v26, 0x3727c5ac, v26
  v_cvt_pk_bf16_f32 v25, v26, v26
  v_lshlrev_b32 v26, 16, v25
  v_sqrt_f32 v26, v26
  s_nop 0
  v_cvt_pk_bf16_f32 v25, v26, v26
  v_lshlrev_b32 v26, 16, v25
  v_rcp_f32 v26, v26
  v_cvt_pk_bf16_f32 v25, v24, v24
  v_lshlrev_b32 v24, 16, v25
  v_sub_f32 v16, v16, v24
  v_cvt_pk_bf16_f32 v25, v16, v16
  v_lshlrev_b32 v16, 16, v25
  v_mul_f32 v16, v16, v26
  v_cvt_pk_bf16_f32 v25, v16, v16
  v_lshlrev_b32 v16, 16, v25
  v_sub_f32 v17, v17, v24
  v_cvt_pk_bf16_f32 v25, v17, v17
  v_lshlrev_b32 v17, 16, v25
  v_mul_f32 v17, v17, v26
  v_cvt_pk_bf16_f32 v25, v17, v17
  v_lshlrev_b32 v17, 16, v25
  v_sub_f32 v18, v18, v24
  v_cvt_pk_bf16_f32 v25, v18, v18
  v_lshlrev_b32 v18, 16, v25
  v_mul_f32 v18, v18, v26
  v_cvt_pk_bf16_f32 v25, v18, v18
  v_lshlrev_b32 v18, 16, v25
  v_sub_f32 v19, v19, v24
  v_cvt_pk_bf16_f32 v25, v19, v19
  v_lshlrev_b32 v19, 16, v25
  v_mul_f32 v19, v19, v26
  v_cvt_pk_bf16_f32 v25, v19, v19
  v_lshlrev_b32 v19, 16, v25
  v_sub_f32 v20, v20, v24
  v_cvt_pk_bf16_f32 v25, v20, v20
  v_lshlrev_b32 v20, 16, v25
  v_mul_f32 v20, v20, v26
  v_cvt_pk_bf16_f32 v25, v20, v20
  v_lshlrev_b32 v20, 16, v25
  v_sub_f32 v21, v21, v24
  v_cvt_pk_bf16_f32 v25, v21, v21
  v_lshlrev_b32 v21, 16, v25
  v_mul_f32 v21, v21, v26
  v_cvt_pk_bf16_f32 v25, v21, v21
  v_lshlrev_b32 v21, 16, v25
  v_sub_f32 v22, v22, v24
  v_cvt_pk_bf16_f32 v25, v22, v22
  v_lshlrev_b32 v22, 16, v25
  v_mul_f32 v22, v22, v26
  v_cvt_pk_bf16_f32 v25, v22, v22
  v_lshlrev_b32 v22, 16, v25
  v_sub_f32 v23, v23, v24
  v_cvt_pk_bf16_f32 v25, v23, v23
  v_lshlrev_b32 v23, 16, v25
  v_mul_f32 v23, v23, v26
  v_cvt_pk_bf16_f32 v25, v23, v23
  v_lshlrev_b32 v23, 16, v25
  v_lshlrev_b32 v7, 11, v2
  v_lshl_add_u32 v28, v1, 5, v7
  ds_write_b128 v28, v[16:19]
  ds_write_b128 v28, v[20:23] offset:16
  v_lshl_add_u32 v28, v4, 2, v7
  s_waitcnt lgkmcnt(0)
  ds_read_b32 v96, v28 offset:0
  ds_read_b32 v97, v28 offset:128
  ds_read_b32 v98, v28 offset:256
  ds_read_b32 v99, v28 offset:384
  ds_read_b32 v100, v28 offset:512
  ds_read_b32 v101, v28 offset:640
  ds_read_b32 v102, v28 offset:768
  ds_read_b32 v103, v28 offset:896
  ds_read_b32 v104, v28 offset:1024
  ds_read_b32 v105, v28 offset:1152
  ds_read_b32 v106, v28 offset:1280
  ds_read_b32 v107, v28 offset:1408
  ds_read_b32 v108, v28 offset:1536
  ds_read_b32 v109, v28 offset:1664
  ds_read_b32 v110, v28 offset:1792
  ds_read_b32 v111, v28 offset:1920
  v_mov_b32 v112, 0
  v_mov_b32 v113, 0
  v_mov_b32 v114, 0
  v_mov_b32 v115, 0
  v_mov_b32 v116, 0
  v_mov_b32 v117, 0
  v_mov_b32 v118, 0
  v_mov_b32 v119, 0
  s_waitcnt lgkmcnt(0)
  s_waitcnt vmcnt(15)
  v_lshlrev_b32 v24, 16, v32
  v_fmac_f32 v112, v96, v24
  v_and_b32 v24, 0xffff0000, v32
  v_fmac_f32 v113, v96, v24
  v_lshlrev_b32 v24, 16, v33
  v_fmac_f32 v114, v96, v24
  v_and_b32 v24, 0xffff0000, v33
  v_fmac_f32 v115, v96, v24
  v_lshlrev_b32 v24, 16, v34
  v_fmac_f32 v116, v96, v24
  v_and_b32 v24, 0xffff0000, v34
  v_fmac_f32 v117, v96, v24
  v_lshlrev_b32 v24, 16, v35
  v_fmac_f32 v118, v96, v24
  v_and_b32 v24, 0xffff0000, v35
  v_fmac_f32 v119, v96, v24
  s_waitcnt vmcnt(14)
  v_lshlrev_b32 v24, 16, v36
  v_fmac_f32 v112, v97, v24
  v_and_b32 v24, 0xffff0000, v36
  v_fmac_f32 v113, v97, v24
  v_lshlrev_b32 v24, 16, v37
  v_fmac_f32 v114, v97, v24
  v_and_b32 v24, 0xffff0000, v37
  v_fmac_f32 v115, v97, v24
  v_lshlrev_b32 v24, 16, v38
  v_fmac_f32 v116, v97, v24
  v_and_b32 v24, 0xffff0000, v38
  v_fmac_f32 v117, v97, v24
  v_lshlrev_b32 v24, 16, v39
  v_fmac_f32 v118, v97, v24
  v_and_b32 v24, 0xffff0000, v39
  v_fmac_f32 v119, v97, v24
  s_waitcnt vmcnt(13)
  v_lshlrev_b32 v24, 16, v40
  v_fmac_f32 v112, v98, v24
  v_and_b32 v24, 0xffff0000, v40
  v_fmac_f32 v113, v98, v24
  v_lshlrev_b32 v24, 16, v41
  v_fmac_f32 v114, v98, v24
  v_and_b32 v24, 0xffff0000, v41
  v_fmac_f32 v115, v98, v24
  v_lshlrev_b32 v24, 16, v42
  v_fmac_f32 v116, v98, v24
  v_and_b32 v24, 0xffff0000, v42
  v_fmac_f32 v117, v98, v24
  v_lshlrev_b32 v24, 16, v43
  v_fmac_f32 v118, v98, v24
  v_and_b32 v24, 0xffff0000, v43
  v_fmac_f32 v119, v98, v24
  s_waitcnt vmcnt(12)
  v_lshlrev_b32 v24, 16, v44
  v_fmac_f32 v112, v99, v24
  v_and_b32 v24, 0xffff0000, v44
  v_fmac_f32 v113, v99, v24
  v_lshlrev_b32 v24, 16, v45
  v_fmac_f32 v114, v99, v24
  v_and_b32 v24, 0xffff0000, v45
  v_fmac_f32 v115, v99, v24
  v_lshlrev_b32 v24, 16, v46
  v_fmac_f32 v116, v99, v24
  v_and_b32 v24, 0xffff0000, v46
  v_fmac_f32 v117, v99, v24
  v_lshlrev_b32 v24, 16, v47
  v_fmac_f32 v118, v99, v24
  v_and_b32 v24, 0xffff0000, v47
  v_fmac_f32 v119, v99, v24
  s_waitcnt vmcnt(11)
  v_lshlrev_b32 v24, 16, v48
  v_fmac_f32 v112, v100, v24
  v_and_b32 v24, 0xffff0000, v48
  v_fmac_f32 v113, v100, v24
  v_lshlrev_b32 v24, 16, v49
  v_fmac_f32 v114, v100, v24
  v_and_b32 v24, 0xffff0000, v49
  v_fmac_f32 v115, v100, v24
  v_lshlrev_b32 v24, 16, v50
  v_fmac_f32 v116, v100, v24
  v_and_b32 v24, 0xffff0000, v50
  v_fmac_f32 v117, v100, v24
  v_lshlrev_b32 v24, 16, v51
  v_fmac_f32 v118, v100, v24
  v_and_b32 v24, 0xffff0000, v51
  v_fmac_f32 v119, v100, v24
  s_waitcnt vmcnt(10)
  v_lshlrev_b32 v24, 16, v52
  v_fmac_f32 v112, v101, v24
  v_and_b32 v24, 0xffff0000, v52
  v_fmac_f32 v113, v101, v24
  v_lshlrev_b32 v24, 16, v53
  v_fmac_f32 v114, v101, v24
  v_and_b32 v24, 0xffff0000, v53
  v_fmac_f32 v115, v101, v24
  v_lshlrev_b32 v24, 16, v54
  v_fmac_f32 v116, v101, v24
  v_and_b32 v24, 0xffff0000, v54
  v_fmac_f32 v117, v101, v24
  v_lshlrev_b32 v24, 16, v55
  v_fmac_f32 v118, v101, v24
  v_and_b32 v24, 0xffff0000, v55
  v_fmac_f32 v119, v101, v24
  s_waitcnt vmcnt(9)
  v_lshlrev_b32 v24, 16, v56
  v_fmac_f32 v112, v102, v24
  v_and_b32 v24, 0xffff0000, v56
  v_fmac_f32 v113, v102, v24
  v_lshlrev_b32 v24, 16, v57
  v_fmac_f32 v114, v102, v24
  v_and_b32 v24, 0xffff0000, v57
  v_fmac_f32 v115, v102, v24
  v_lshlrev_b32 v24, 16, v58
  v_fmac_f32 v116, v102, v24
  v_and_b32 v24, 0xffff0000, v58
  v_fmac_f32 v117, v102, v24
  v_lshlrev_b32 v24, 16, v59
  v_fmac_f32 v118, v102, v24
  v_and_b32 v24, 0xffff0000, v59
  v_fmac_f32 v119, v102, v24
  s_waitcnt vmcnt(8)
  v_lshlrev_b32 v24, 16, v60
  v_fmac_f32 v112, v103, v24
  v_and_b32 v24, 0xffff0000, v60
  v_fmac_f32 v113, v103, v24
  v_lshlrev_b32 v24, 16, v61
  v_fmac_f32 v114, v103, v24
  v_and_b32 v24, 0xffff0000, v61
  v_fmac_f32 v115, v103, v24
  v_lshlrev_b32 v24, 16, v62
  v_fmac_f32 v116, v103, v24
  v_and_b32 v24, 0xffff0000, v62
  v_fmac_f32 v117, v103, v24
  v_lshlrev_b32 v24, 16, v63
  v_fmac_f32 v118, v103, v24
  v_and_b32 v24, 0xffff0000, v63
  v_fmac_f32 v119, v103, v24
  s_waitcnt vmcnt(7)
  v_lshlrev_b32 v24, 16, v64
  v_fmac_f32 v112, v104, v24
  v_and_b32 v24, 0xffff0000, v64
  v_fmac_f32 v113, v104, v24
  v_lshlrev_b32 v24, 16, v65
  v_fmac_f32 v114, v104, v24
  v_and_b32 v24, 0xffff0000, v65
  v_fmac_f32 v115, v104, v24
  v_lshlrev_b32 v24, 16, v66
  v_fmac_f32 v116, v104, v24
  v_and_b32 v24, 0xffff0000, v66
  v_fmac_f32 v117, v104, v24
  v_lshlrev_b32 v24, 16, v67
  v_fmac_f32 v118, v104, v24
  v_and_b32 v24, 0xffff0000, v67
  v_fmac_f32 v119, v104, v24
  s_waitcnt vmcnt(6)
  v_lshlrev_b32 v24, 16, v68
  v_fmac_f32 v112, v105, v24
  v_and_b32 v24, 0xffff0000, v68
  v_fmac_f32 v113, v105, v24
  v_lshlrev_b32 v24, 16, v69
  v_fmac_f32 v114, v105, v24
  v_and_b32 v24, 0xffff0000, v69
  v_fmac_f32 v115, v105, v24
  v_lshlrev_b32 v24, 16, v70
  v_fmac_f32 v116, v105, v24
  v_and_b32 v24, 0xffff0000, v70
  v_fmac_f32 v117, v105, v24
  v_lshlrev_b32 v24, 16, v71
  v_fmac_f32 v118, v105, v24
  v_and_b32 v24, 0xffff0000, v71
  v_fmac_f32 v119, v105, v24
  s_waitcnt vmcnt(5)
  v_lshlrev_b32 v24, 16, v72
  v_fmac_f32 v112, v106, v24
  v_and_b32 v24, 0xffff0000, v72
  v_fmac_f32 v113, v106, v24
  v_lshlrev_b32 v24, 16, v73
  v_fmac_f32 v114, v106, v24
  v_and_b32 v24, 0xffff0000, v73
  v_fmac_f32 v115, v106, v24
  v_lshlrev_b32 v24, 16, v74
  v_fmac_f32 v116, v106, v24
  v_and_b32 v24, 0xffff0000, v74
  v_fmac_f32 v117, v106, v24
  v_lshlrev_b32 v24, 16, v75
  v_fmac_f32 v118, v106, v24
  v_and_b32 v24, 0xffff0000, v75
  v_fmac_f32 v119, v106, v24
  s_waitcnt vmcnt(4)
  v_lshlrev_b32 v24, 16, v76
  v_fmac_f32 v112, v107, v24
  v_and_b32 v24, 0xffff0000, v76
  v_fmac_f32 v113, v107, v24
  v_lshlrev_b32 v24, 16, v77
  v_fmac_f32 v114, v107, v24
  v_and_b32 v24, 0xffff0000, v77
  v_fmac_f32 v115, v107, v24
  v_lshlrev_b32 v24, 16, v78
  v_fmac_f32 v116, v107, v24
  v_and_b32 v24, 0xffff0000, v78
  v_fmac_f32 v117, v107, v24
  v_lshlrev_b32 v24, 16, v79
  v_fmac_f32 v118, v107, v24
  v_and_b32 v24, 0xffff0000, v79
  v_fmac_f32 v119, v107, v24
  s_waitcnt vmcnt(3)
  v_lshlrev_b32 v24, 16, v80
  v_fmac_f32 v112, v108, v24
  v_and_b32 v24, 0xffff0000, v80
  v_fmac_f32 v113, v108, v24
  v_lshlrev_b32 v24, 16, v81
  v_fmac_f32 v114, v108, v24
  v_and_b32 v24, 0xffff0000, v81
  v_fmac_f32 v115, v108, v24
  v_lshlrev_b32 v24, 16, v82
  v_fmac_f32 v116, v108, v24
  v_and_b32 v24, 0xffff0000, v82
  v_fmac_f32 v117, v108, v24
  v_lshlrev_b32 v24, 16, v83
  v_fmac_f32 v118, v108, v24
  v_and_b32 v24, 0xffff0000, v83
  v_fmac_f32 v119, v108, v24
  s_waitcnt vmcnt(2)
  v_lshlrev_b32 v24, 16, v84
  v_fmac_f32 v112, v109, v24
  v_and_b32 v24, 0xffff0000, v84
  v_fmac_f32 v113, v109, v24
  v_lshlrev_b32 v24, 16, v85
  v_fmac_f32 v114, v109, v24
  v_and_b32 v24, 0xffff0000, v85
  v_fmac_f32 v115, v109, v24
  v_lshlrev_b32 v24, 16, v86
  v_fmac_f32 v116, v109, v24
  v_and_b32 v24, 0xffff0000, v86
  v_fmac_f32 v117, v109, v24
  v_lshlrev_b32 v24, 16, v87
  v_fmac_f32 v118, v109, v24
  v_and_b32 v24, 0xffff0000, v87
  v_fmac_f32 v119, v109, v24
  s_waitcnt vmcnt(1)
  v_lshlrev_b32 v24, 16, v88
  v_fmac_f32 v112, v110, v24
  v_and_b32 v24, 0xffff0000, v88
  v_fmac_f32 v113, v110, v24
  v_lshlrev_b32 v24, 16, v89
  v_fmac_f32 v114, v110, v24
  v_and_b32 v24, 0xffff0000, v89
  v_fmac_f32 v115, v110, v24
  v_lshlrev_b32 v24, 16, v90
  v_fmac_f32 v116, v110, v24
  v_and_b32 v24, 0xffff0000, v90
  v_fmac_f32 v117, v110, v24
  v_lshlrev_b32 v24, 16, v91
  v_fmac_f32 v118, v110, v24
  v_and_b32 v24, 0xffff0000, v91
  v_fmac_f32 v119, v110, v24
  s_waitcnt vmcnt(0)
  v_lshlrev_b32 v24, 16, v92
  v_fmac_f32 v112, v111, v24
  v_and_b32 v24, 0xffff0000, v92
  v_fmac_f32 v113, v111, v24
  v_lshlrev_b32 v24, 16, v93
  v_fmac_f32 v114, v111, v24
  v_and_b32 v24, 0xffff0000, v93
  v_fmac_f32 v115, v111, v24
  v_lshlrev_b32 v24, 16, v94
  v_fmac_f32 v116, v111, v24
  v_and_b32 v24, 0xffff0000, v94
  v_fmac_f32 v117, v111, v24
  v_lshlrev_b32 v24, 16, v95
  v_fmac_f32 v118, v111, v24
  v_and_b32 v24, 0xffff0000, v95
  v_fmac_f32 v119, v111, v24
  s_nop 1
  v_mov_b32_dpp v24, v112 row_ror:8 row_mask:0xf bank_mask:0xf
  v_add_f32 v112, v112, v24
  v_mov_b32 v24, v112
  s_nop 1
  v_permlane16_swap_b32 v112, v24
  v_add_f32 v112, v112, v24
  v_mov_b32 v24, v112
  s_nop 1
  v_permlane32_swap_b32 v112, v24
  v_add_f32 v112, v112, v24
  s_nop 1
  v_mov_b32_dpp v24, v113 row_ror:8 row_mask:0xf bank_mask:0xf
  v_add_f32 v113, v113, v24
  v_mov_b32 v24, v113
  s_nop 1
  v_permlane16_swap_b32 v113, v24
  v_add_f32 v113, v113, v24
  v_mov_b32 v24, v113
  s_nop 1
  v_permlane32_swap_b32 v113, v24
  v_add_f32 v113, v113, v24
  s_nop 1
  v_mov_b32_dpp v24, v114 row_ror:8 row_mask:0xf bank_mask:0xf
  v_add_f32 v114, v114, v24
  v_mov_b32 v24, v114
  s_nop 1
  v_permlane16_swap_b32 v114, v24
  v_add_f32 v114, v114, v24
  v_mov_b32 v24, v114
  s_nop 1
  v_permlane32_swap_b32 v114, v24
  v_add_f32 v114, v114, v24
  s_nop 1
  v_mov_b32_dpp v24, v115 row_ror:8 row_mask:0xf bank_mask:0xf
  v_add_f32 v115, v115, v24
  v_mov_b32 v24, v115
  s_nop 1
  v_permlane16_swap_b32 v115, v24
  v_add_f32 v115, v115, v24
  v_mov_b32 v24, v115
  s_nop 1
  v_permlane32_swap_b32 v115, v24
  v_add_f32 v115, v115, v24
  s_nop 1
  v_mov_b32_dpp v24, v116 row_ror:8 row_mask:0xf bank_mask:0xf
  v_add_f32 v116, v116, v24
  v_mov_b32 v24, v116
  s_nop 1
  v_permlane16_swap_b32 v116, v24
  v_add_f32 v116, v116, v24
  v_mov_b32 v24, v116
  s_nop 1
  v_permlane32_swap_b32 v116, v24
  v_add_f32 v116, v116, v24
  s_nop 1
  v_mov_b32_dpp v24, v117 row_ror:8 row_mask:0xf bank_mask:0xf
  v_add_f32 v117, v117, v24
  v_mov_b32 v24, v117
  s_nop 1
  v_permlane16_swap_b32 v117, v24
  v_add_f32 v117, v117, v24
  v_mov_b32 v24, v117
  s_nop 1
  v_permlane32_swap_b32 v117, v24
  v_add_f32 v117, v117, v24
  s_nop 1
  v_mov_b32_dpp v24, v118 row_ror:8 row_mask:0xf bank_mask:0xf
  v_add_f32 v118, v118, v24
  v_mov_b32 v24, v118
  s_nop 1
  v_permlane16_swap_b32 v118, v24
  v_add_f32 v118, v118, v24
  v_mov_b32 v24, v118
  s_nop 1
  v_permlane32_swap_b32 v118, v24
  v_add_f32 v118, v118, v24
  s_nop 1
  v_mov_b32_dpp v24, v119 row_ror:8 row_mask:0xf bank_mask:0xf
  v_add_f32 v119, v119, v24
  v_mov_b32 v24, v119
  s_nop 1
  v_permlane16_swap_b32 v119, v24
  v_add_f32 v119, v119, v24
  v_mov_b32 v24, v119
  s_nop 1
  v_permlane32_swap_b32 v119, v24
  v_add_f32 v119, v119, v24
  v_lshlrev_b32 v7, 8, v2
  v_lshl_add_u32 v7, v1, 5, v7
  v_add_u32 v7, 8192, v7
  v_cmp_gt_u32 vcc, 8, v1
  s_and_saveexec_b64 s[10:11], vcc
  ds_write_b128 v7, v[112:115]
  ds_write_b128 v7, v[116:119] offset:16
  s_mov_b64 exec, s[10:11]
  s_waitcnt lgkmcnt(0)
  s_barrier
  v_cmp_gt_u32 vcc, 64, v0
  s_and_saveexec_b64 s[10:11], vcc
  s_cbranch_execz L_q_end
  v_lshlrev_b32 v7, 2, v0
  ds_read_b32 v8, v7 offset:8192
  ds_read_b32 v9, v7 offset:8448
  ds_read_b32 v10, v7 offset:8704
  ds_read_b32 v11, v7 offset:8960
  s_waitcnt lgkmcnt(0)
  v_add_f32 v8, v8, v9
  v_add_f32 v10, v10, v11
  v_add_f32 v8, v8, v10
  v_cvt_pk_bf16_f32 v8, v8, v8
  v_lshlrev_b32 v7, 1, v0
  v_add_u32 v7, s3, v7
  global_store_short v7, v8, s[8:9]
L_q_end:
  s_endpgm
.section .rodata,"a"
.p2align 6
.amdhsa_kernel qproj_kernel
  .amdhsa_next_free_vgpr 128
  .amdhsa_next_free_sgpr 96
  .amdhsa_accum_offset 128
  .amdhsa_group_segment_fixed_size 0
  .amdhsa_kernarg_size 104
  .amdhsa_user_sgpr_count 2
  .amdhsa_user_sgpr_kernarg_segment_ptr 1
  .amdhsa_system_sgpr_workgroup_id_x 1
.end_amdhsa_kernel
.text
.globl attn_kernel
.p2align 8
.type attn_kernel,@function
attn_kernel:
  s_cmp_ge_u32 s2, 256
  s_cbranch_scc1 L_a_end
  s_load_dwordx2 s[4:5], s[0:1], 8
  s_load_dwordx2 s[6:7], s[0:1], 16
  s_load_dwordx2 s[8:9], s[0:1], 96
  v_and_b32 v1, 63, v0
  v_lshrrev_b32 v2, 6, v0
  s_nop 0
  v_readfirstlane_b32 s12, v2
  s_lshr_b32 s13, s2, 5
  s_and_b32 s14, s2, 31
  v_and_b32 v2, 15, v1
  v_lshrrev_b32 v3, 4, v1
  v_and_b32 v160, 3, v2
  v_lshlrev_b32 v160, 8, v160
  v_lshl_add_u32 v160, v3, 4, v160
  s_lshl_b32 s15, s13, 10
  v_add_u32 v160, s15, v160
  v_lshlrev_b32 v152, 8, v2
  v_lshl_add_u32 v152, v3, 4, v152
  v_add_u32 v153, 4096, v152
  v_lshlrev_b32 v161, 1, v3
  v_xor_b32 v162, v2, v161
  v_lshlrev_b32 v162, 4, v162
  v_lshl_add_u32 v154, v3, 8, v162
  v_lshlrev_b32 v162, 4, v2
  v_lshlrev_b32 v163, 5, v3
  v_xor_b32 v162, v162, v163
  v_xor_b32 v162, 128, v162
  v_lshl_add_u32 v155, v3, 8, v162
  v_add_u32 v156, 4096, v154
  v_add_u32 v157, 4096, v155
  v_lshrrev_b32 v161, 2, v2
  v_lshl_add_u32 v161, v3, 2, v161
  v_and_b32 v162, 7, v161
  v_and_b32 v163, 3, v2
  v_lshlrev_b32 v164, 8, v161
  v_lshl_add_u32 v164, v163, 3, v164
  s_lshl_b32 s16, s12, 14
  v_add_u32 v164, s16, v164
  v_xor_b32 v165, 0, v162
  v_lshl_add_u32 v144, v165, 5, v164
  v_xor_b32 v165, 1, v162
  v_lshl_add_u32 v145, v165, 5, v164
  v_xor_b32 v165, 2, v162
  v_lshl_add_u32 v146, v165, 5, v164
  v_xor_b32 v165, 3, v162
  v_lshl_add_u32 v147, v165, 5, v164
  v_xor_b32 v165, 4, v162
  v_lshl_add_u32 v148, v165, 5, v164
  v_xor_b32 v165, 5, v162
  v_lshl_add_u32 v149, v165, 5, v164
  v_xor_b32 v165, 6, v162
  v_lshl_add_u32 v150, v165, 5, v164
  v_xor_b32 v165, 7, v162
  v_lshl_add_u32 v151, v165, 5, v164
  s_lshl_b32 s17, s13, 24
  s_lshl_b32 s18, s14, 19
  s_add_u32 s17, s17, s18
  s_lshl_b32 s18, s12, 13
  s_add_u32 s17, s17, s18
  s_waitcnt lgkmcnt(0)
  s_add_u32 s20, s4, s17
  s_addc_u32 s21, s5, 0
  s_add_u32 s22, s6, s17
  s_addc_u32 s23, s7, 0
  global_load_dwordx4 v[4:7], v160, s[8:9] offset:0
  global_load_dwordx4 v[8:11], v160, s[8:9] offset:64
  global_load_dwordx4 v[12:15], v160, s[8:9] offset:128
  global_load_dwordx4 v[16:19], v160, s[8:9] offset:192
  v_mov_b32 v84, 0
  v_mov_b32 v85, 0
  v_mov_b32 v86, 0
  v_mov_b32 v87, 0
  v_mov_b32 v88, 0
  v_mov_b32 v89, 0
  v_mov_b32 v90, 0
  v_mov_b32 v91, 0
  v_mov_b32 v92, 0
  v_mov_b32 v93, 0
  v_mov_b32 v94, 0
  v_mov_b32 v95, 0
  v_mov_b32 v96, 0
  v_mov_b32 v97, 0
  v_mov_b32 v98, 0
  v_mov_b32 v99, 0
  v_mov_b32 v100, 0
  v_mov_b32 v101, 0
  v_mov_b32 v102, 0
  v_mov_b32 v103, 0
  v_mov_b32 v104, 0
  v_mov_b32 v105, 0
  v_mov_b32 v106, 0
  v_mov_b32 v107, 0
  v_mov_b32 v108, 0
  v_mov_b32 v109, 0
  v_mov_b32 v110, 0
  v_mov_b32 v111, 0
  v_mov_b32 v112, 0
  v_mov_b32 v113, 0
  v_mov_b32 v114, 0
  v_mov_b32 v115, 0
  v_mov_b32 v158, 0xf149f2ca
  v_mov_b32 v159, 0
  global_load_dwordx4 v[20:23], v152, s[20:21] offset:0
  global_load_dwordx4 v[24:27], v152, s[20:21] offset:64
  global_load_dwordx4 v[28:31], v152, s[20:21] offset:128
  global_load_dwordx4 v[32:35], v152, s[20:21] offset:192
  global_load_dwordx4 v[36:39], v153, s[20:21] offset:0
  global_load_dwordx4 v[40:43], v153, s[20:21] offset:64
  global_load_dwordx4 v[44:47], v153, s[20:21] offset:128
  global_load_dwordx4 v[48:51], v153, s[20:21] offset:192
  s_add_u32 s24, s16, 0
  s_mov_b32 m0, s24
  s_nop 0
  global_load_lds_dwordx4 v154, s[22:23] offset:0 nt
  global_load_lds_dwordx4 v155, s[22:23] offset:1024 nt
  global_load_lds_dwordx4 v154, s[22:23] offset:2048 nt
  global_load_lds_dwordx4 v155, s[22:23] offset:3072 nt
  s_add_u32 s24, s16, 4096
  s_mov_b32 m0, s24
  s_nop 0
  global_load_lds_dwordx4 v156, s[22:23] offset:0 nt
  global_load_lds_dwordx4 v157, s[22:23] offset:1024 nt
  global_load_lds_dwordx4 v156, s[22:23] offset:2048 nt
  global_load_lds_dwordx4 v157, s[22:23] offset:3072 nt
  s_add_u32 s20, s20, 0x10000
  s_addc_u32 s21, s21, 0
  s_add_u32 s22, s22, 0x10000
  s_addc_u32 s23, s23, 0
  global_load_dwordx4 v[52:55], v152, s[20:21] offset:0
  global_load_dwordx4 v[56:59], v152, s[20:21] offset:64
  global_load_dwordx4 v[60:63], v152, s[20:21] offset:128
  global_load_dwordx4 v[64:67], v152, s[20:21] offset:192
  global_load_dwordx4 v[68:71], v153, s[20:21] offset:0
  global_load_dwordx4 v[72:75], v153, s[20:21] offset:64
  global_load_dwordx4 v[76:79], v153, s[20:21] offset:128
  global_load_dwordx4 v[80:83], v153, s[20:21] offset:192
  s_add_u32 s24, s16, 8192
  s_mov_b32 m0, s24
  s_nop 0
  global_load_lds_dwordx4 v154, s[22:23] offset:0 nt
  global_load_lds_dwordx4 v155, s[22:23] offset:1024 nt
  global_load_lds_dwordx4 v154, s[22:23] offset:2048 nt
  global_load_lds_dwordx4 v155, s[22:23] offset:3072 nt
  s_add_u32 s24, s16, 12288
  s_mov_b32 m0, s24
  s_nop 0
  global_load_lds_dwordx4 v156, s[22:23] offset:0 nt
  global_load_lds_dwordx4 v157, s[22:23] offset:1024 nt
  global_load_lds_dwordx4 v156, s[22:23] offset:2048 nt
  global_load_lds_dwordx4 v157, s[22:23] offset:3072 nt
  s_add_u32 s20, s20, 0x10000
  s_addc_u32 s21, s21, 0
  s_add_u32 s22, s22, 0x10000
  s_addc_u32 s23, s23, 0
  s_waitcnt vmcnt(16)
  v_mfma_f32_16x16x32_bf16 v[116:119], v[20:23], v[4:7], 0
  v_mfma_f32_16x16x32_bf16 v[116:119], v[24:27], v[8:11], v[116:119]
  v_mfma_f32_16x16x32_bf16 v[116:119], v[28:31], v[12:15], v[116:119]
  v_mfma_f32_16x16x32_bf16 v[116:119], v[32:35], v[16:19], v[116:119]
  v_mfma_f32_16x16x32_bf16 v[120:123], v[36:39], v[4:7], 0
  v_mfma_f32_16x16x32_bf16 v[120:123], v[40:43], v[8:11], v[120:123]
  v_mfma_f32_16x16x32_bf16 v[120:123], v[44:47], v[12:15], v[120:123]
  v_mfma_f32_16x16x32_bf16 v[120:123], v[48:51], v[16:19], v[120:123]
  ds_read_b64_tr_b16 v[128:129], v144 offset:0
  ds_read_b64_tr_b16 v[130:131], v144 offset:4096
  ds_read_b64_tr_b16 v[132:133], v145 offset:0
  ds_read_b64_tr_b16 v[134:135], v145 offset:4096
  ds_read_b64_tr_b16 v[136:137], v146 offset:0
  ds_read_b64_tr_b16 v[138:139], v146 offset:4096
  ds_read_b64_tr_b16 v[140:141], v147 offset:0
  ds_read_b64_tr_b16 v[142:143], v147 offset:4096
  s_nop 7
  v_cvt_pk_bf16_f32 v160, v116, v116
  v_lshlrev_b32 v116, 16, v160
  v_mul_f32 v116, 0x3db504f3, v116
  v_cvt_pk_bf16_f32 v160, v116, v116
  v_lshlrev_b32 v116, 16, v160
  v_cvt_pk_bf16_f32 v160, v117, v117
  v_lshlrev_b32 v117, 16, v160
  v_mul_f32 v117, 0x3db504f3, v117
  v_cvt_pk_bf16_f32 v160, v117, v117
  v_lshlrev_b32 v117, 16, v160
  v_cvt_pk_bf16_f32 v160, v118, v118
  v_lshlrev_b32 v118, 16, v160
  v_mul_f32 v118, 0x3db504f3, v118
  v_cvt_pk_bf16_f32 v160, v118, v118
  v_lshlrev_b32 v118, 16, v160
  v_cvt_pk_bf16_f32 v160, v119, v119
  v_lshlrev_b32 v119, 16, v160
  v_mul_f32 v119, 0x3db504f3, v119
  v_cvt_pk_bf16_f32 v160, v119, v119
  v_lshlrev_b32 v119, 16, v160
  v_cvt_pk_bf16_f32 v160, v120, v120
  v_lshlrev_b32 v120, 16, v160
  v_mul_f32 v120, 0x3db504f3, v120
  v_cvt_pk_bf16_f32 v160, v120, v120
  v_lshlrev_b32 v120, 16, v160
  v_cvt_pk_bf16_f32 v160, v121, v121
  v_lshlrev_b32 v121, 16, v160
  v_mul_f32 v121, 0x3db504f3, v121
  v_cvt_pk_bf16_f32 v160, v121, v121
  v_lshlrev_b32 v121, 16, v160
  v_cvt_pk_bf16_f32 v160, v122, v122
  v_lshlrev_b32 v122, 16, v160
  v_mul_f32 v122, 0x3db504f3, v122
  v_cvt_pk_bf16_f32 v160, v122, v122
  v_lshlrev_b32 v122, 16, v160
  v_cvt_pk_bf16_f32 v160, v123, v123
  v_lshlrev_b32 v123, 16, v160
  v_mul_f32 v123, 0x3db504f3, v123
  v_cvt_pk_bf16_f32 v160, v123, v123
  v_lshlrev_b32 v123, 16, v160
  v_max3_f32 v160, v116, v117, v118
  v_max3_f32 v160, v119, v120, v160
  v_max3_f32 v160, v121, v122, v160
  v_max_f32 v160, v123, v160
  v_mov_b32 v161, v160
  s_nop 1
  v_permlane16_swap_b32 v160, v161
  v_max_f32 v160, v160, v161
  v_mov_b32 v161, v160
  s_nop 1
  v_permlane32_swap_b32 v160, v161
  v_max_f32 v160, v160, v161
  v_max_f32 v160, v160, v158
  v_sub_f32 v161, v158, v160
  v_mul_f32 v161, 0x3fb8aa3b, v161
  v_exp_f32 v161, v161
  v_mov_b32 v158, v160
  v_sub_f32 v116, v116, v160
  v_mul_f32 v116, 0x3fb8aa3b, v116
  v_exp_f32 v116, v116
  v_sub_f32 v117, v117, v160
  v_mul_f32 v117, 0x3fb8aa3b, v117
  v_exp_f32 v117, v117
  v_sub_f32 v118, v118, v160
  v_mul_f32 v118, 0x3fb8aa3b, v118
  v_exp_f32 v118, v118
  v_sub_f32 v119, v119, v160
  v_mul_f32 v119, 0x3fb8aa3b, v119
  v_exp_f32 v119, v119
  v_sub_f32 v120, v120, v160
  v_mul_f32 v120, 0x3fb8aa3b, v120
  v_exp_f32 v120, v120
  v_sub_f32 v121, v121, v160
  v_mul_f32 v121, 0x3fb8aa3b, v121
  v_exp_f32 v121, v121
  v_sub_f32 v122, v122, v160
  v_mul_f32 v122, 0x3fb8aa3b, v122
  v_exp_f32 v122, v122
  v_sub_f32 v123, v123, v160
  v_mul_f32 v123, 0x3fb8aa3b, v123
  v_exp_f32 v123, v123
  v_mul_f32 v159, v159, v161
  v_cvt_pk_bf16_f32 v124, v116, v117
  v_cvt_pk_bf16_f32 v125, v118, v119
  v_cvt_pk_bf16_f32 v126, v120, v121
  v_cvt_pk_bf16_f32 v127, v122, v123
  v_add_f32 v159, v159, v116
  v_add_f32 v159, v159, v117
  v_add_f32 v159, v159, v118
  v_add_f32 v159, v159, v119
  v_add_f32 v159, v159, v120
  v_add_f32 v159, v159, v121
  v_add_f32 v159, v159, v122
  v_add_f32 v159, v159, v123
  v_readlane_b32 s30, v161, 0
  v_readlane_b32 s31, v161, 1
  v_readlane_b32 s32, v161, 2
  v_readlane_b32 s33, v161, 3
  s_nop 1
  v_mul_f32 v84, s30, v84
  v_mul_f32 v85, s31, v85
  v_mul_f32 v86, s32, v86
  v_mul_f32 v87, s33, v87
  v_mul_f32 v88, s30, v88
  v_mul_f32 v89, s31, v89
  v_mul_f32 v90, s32, v90
  v_mul_f32 v91, s33, v91
  v_mul_f32 v92, s30, v92
  v_mul_f32 v93, s31, v93
  v_mul_f32 v94, s32, v94
  v_mul_f32 v95, s33, v95
  v_mul_f32 v96, s30, v96
  v_mul_f32 v97, s31, v97
  v_mul_f32 v98, s32, v98
  v_mul_f32 v99, s33, v99
  v_mul_f32 v100, s30, v100
  v_mul_f32 v101, s31, v101
  v_mul_f32 v102, s32, v102
  v_mul_f32 v103, s33, v103
  v_mul_f32 v104, s30, v104
  v_mul_f32 v105, s31, v105
  v_mul_f32 v106, s32, v106
  v_mul_f32 v107, s33, v107
  v_mul_f32 v108, s30, v108
  v_mul_f32 v109, s31, v109
  v_mul_f32 v110, s32, v110
  v_mul_f32 v111, s33, v111
  v_mul_f32 v112, s30, v112
  v_mul_f32 v113, s31, v113
  v_mul_f32 v114, s32, v114
  v_mul_f32 v115, s33, v115
  s_waitcnt lgkmcnt(0)
  v_mfma_f32_16x16x32_bf16 v[84:87], v[124:127], v[128:131], v[84:87]
  v_mfma_f32_16x16x32_bf16 v[88:91], v[124:127], v[132:135], v[88:91]
  v_mfma_f32_16x16x32_bf16 v[92:95], v[124:127], v[136:139], v[92:95]
  v_mfma_f32_16x16x32_bf16 v[96:99], v[124:127], v[140:143], v[96:99]
  ds_read_b64_tr_b16 v[128:129], v148 offset:0
  ds_read_b64_tr_b16 v[130:131], v148 offset:4096
  ds_read_b64_tr_b16 v[132:133], v149 offset:0
  ds_read_b64_tr_b16 v[134:135], v149 offset:4096
  ds_read_b64_tr_b16 v[136:137], v150 offset:0
  ds_read_b64_tr_b16 v[138:139], v150 offset:4096
  ds_read_b64_tr_b16 v[140:141], v151 offset:0
  ds_read_b64_tr_b16 v[142:143], v151 offset:4096
  s_waitcnt lgkmcnt(0)
  v_mfma_f32_16x16x32_bf16 v[100:103], v[124:127], v[128:131], v[100:103]
  v_mfma_f32_16x16x32_bf16 v[104:107], v[124:127], v[132:135], v[104:107]
  v_mfma_f32_16x16x32_bf16 v[108:111], v[124:127], v[136:139], v[108:111]
  v_mfma_f32_16x16x32_bf16 v[112:115], v[124:127], v[140:143], v[112:115]
  s_nop 7
  global_load_dwordx4 v[20:23], v152, s[20:21] offset:0
  global_load_dwordx4 v[24:27], v152, s[20:21] offset:64
  global_load_dwordx4 v[28:31], v152, s[20:21] offset:128
  global_load_dwordx4 v[32:35], v152, s[20:21] offset:192
  global_load_dwordx4 v[36:39], v153, s[20:21] offset:0
  global_load_dwordx4 v[40:43], v153, s[20:21] offset:64
  global_load_dwordx4 v[44:47], v153, s[20:21] offset:128
  global_load_dwordx4 v[48:51], v153, s[20:21] offset:192
  s_add_u32 s24, s16, 0
  s_mov_b32 m0, s24
  s_nop 0
  global_load_lds_dwordx4 v154, s[22:23] offset:0 nt
  global_load_lds_dwordx4 v155, s[22:23] offset:1024 nt
  global_load_lds_dwordx4 v154, s[22:23] offset:2048 nt
  global_load_lds_dwordx4 v155, s[22:23] offset:3072 nt
  s_add_u32 s24, s16, 4096
  s_mov_b32 m0, s24
  s_nop 0
  global_load_lds_dwordx4 v156, s[22:23] offset:0 nt
  global_load_lds_dwordx4 v157, s[22:23] offset:1024 nt
  global_load_lds_dwordx4 v156, s[22:23] offset:2048 nt
  global_load_lds_dwordx4 v157, s[22:23] offset:3072 nt
  s_add_u32 s20, s20, 0x10000
  s_addc_u32 s21, s21, 0
  s_add_u32 s22, s22, 0x10000
  s_addc_u32 s23, s23, 0
  s_waitcnt vmcnt(16)
  v_mfma_f32_16x16x32_bf16 v[116:119], v[52:55], v[4:7], 0
  v_mfma_f32_16x16x32_bf16 v[116:119], v[56:59], v[8:11], v[116:119]
  v_mfma_f32_16x16x32_bf16 v[116:119], v[60:63], v[12:15], v[116:119]
  v_mfma_f32_16x16x32_bf16 v[116:119], v[64:67], v[16:19], v[116:119]
  v_mfma_f32_16x16x32_bf16 v[120:123], v[68:71], v[4:7], 0
  v_mfma_f32_16x16x32_bf16 v[120:123], v[72:75], v[8:11], v[120:123]
  v_mfma_f32_16x16x32_bf16 v[120:123], v[76:79], v[12:15], v[120:123]
  v_mfma_f32_16x16x32_bf16 v[120:123], v[80:83], v[16:19], v[120:123]
  ds_read_b64_tr_b16 v[128:129], v144 offset:8192
  ds_read_b64_tr_b16 v[130:131], v144 offset:12288
  ds_read_b64_tr_b16 v[132:133], v145 offset:8192
  ds_read_b64_tr_b16 v[134:135], v145 offset:12288
  ds_read_b64_tr_b16 v[136:137], v146 offset:8192
  ds_read_b64_tr_b16 v[138:139], v146 offset:12288
  ds_read_b64_tr_b16 v[140:141], v147 offset:8192
  ds_read_b64_tr_b16 v[142:143], v147 offset:12288
  s_nop 7
  v_cvt_pk_bf16_f32 v160, v116, v116
  v_lshlrev_b32 v116, 16, v160
  v_mul_f32 v116, 0x3db504f3, v116
  v_cvt_pk_bf16_f32 v160, v116, v116
  v_lshlrev_b32 v116, 16, v160
  v_cvt_pk_bf16_f32 v160, v117, v117
  v_lshlrev_b32 v117, 16, v160
  v_mul_f32 v117, 0x3db504f3, v117
  v_cvt_pk_bf16_f32 v160, v117, v117
  v_lshlrev_b32 v117, 16, v160
  v_cvt_pk_bf16_f32 v160, v118, v118
  v_lshlrev_b32 v118, 16, v160
  v_mul_f32 v118, 0x3db504f3, v118
  v_cvt_pk_bf16_f32 v160, v118, v118
  v_lshlrev_b32 v118, 16, v160
  v_cvt_pk_bf16_f32 v160, v119, v119
  v_lshlrev_b32 v119, 16, v160
  v_mul_f32 v119, 0x3db504f3, v119
  v_cvt_pk_bf16_f32 v160, v119, v119
  v_lshlrev_b32 v119, 16, v160
  v_cvt_pk_bf16_f32 v160, v120, v120
  v_lshlrev_b32 v120, 16, v160
  v_mul_f32 v120, 0x3db504f3, v120
  v_cvt_pk_bf16_f32 v160, v120, v120
  v_lshlrev_b32 v120, 16, v160
  v_cvt_pk_bf16_f32 v160, v121, v121
  v_lshlrev_b32 v121, 16, v160
  v_mul_f32 v121, 0x3db504f3, v121
  v_cvt_pk_bf16_f32 v160, v121, v121
  v_lshlrev_b32 v121, 16, v160
  v_cvt_pk_bf16_f32 v160, v122, v122
  v_lshlrev_b32 v122, 16, v160
  v_mul_f32 v122, 0x3db504f3, v122
  v_cvt_pk_bf16_f32 v160, v122, v122
  v_lshlrev_b32 v122, 16, v160
  v_cvt_pk_bf16_f32 v160, v123, v123
  v_lshlrev_b32 v123, 16, v160
  v_mul_f32 v123, 0x3db504f3, v123
  v_cvt_pk_bf16_f32 v160, v123, v123
  v_lshlrev_b32 v123, 16, v160
  v_max3_f32 v160, v116, v117, v118
  v_max3_f32 v160, v119, v120, v160
  v_max3_f32 v160, v121, v122, v160
  v_max_f32 v160, v123, v160
  v_mov_b32 v161, v160
  s_nop 1
  v_permlane16_swap_b32 v160, v161
  v_max_f32 v160, v160, v161
  v_mov_b32 v161, v160
  s_nop 1
  v_permlane32_swap_b32 v160, v161
  v_max_f32 v160, v160, v161
  v_max_f32 v160, v160, v158
  v_sub_f32 v161, v158, v160
  v_mul_f32 v161, 0x3fb8aa3b, v161
  v_exp_f32 v161, v161
  v_mov_b32 v158, v160
  v_sub_f32 v116, v116, v160
  v_mul_f32 v116, 0x3fb8aa3b, v116
  v_exp_f32 v116, v116
  v_sub_f32 v117, v117, v160
  v_mul_f32 v117, 0x3fb8aa3b, v117
  v_exp_f32 v117, v117
  v_sub_f32 v118, v118, v160
  v_mul_f32 v118, 0x3fb8aa3b, v118
  v_exp_f32 v118, v118
  v_sub_f32 v119, v119, v160
  v_mul_f32 v119, 0x3fb8aa3b, v119
  v_exp_f32 v119, v119
  v_sub_f32 v120, v120, v160
  v_mul_f32 v120, 0x3fb8aa3b, v120
  v_exp_f32 v120, v120
  v_sub_f32 v121, v121, v160
  v_mul_f32 v121, 0x3fb8aa3b, v121
  v_exp_f32 v121, v121
  v_sub_f32 v122, v122, v160
  v_mul_f32 v122, 0x3fb8aa3b, v122
  v_exp_f32 v122, v122
  v_sub_f32 v123, v123, v160
  v_mul_f32 v123, 0x3fb8aa3b, v123
  v_exp_f32 v123, v123
  v_mul_f32 v159, v159, v161
  v_cvt_pk_bf16_f32 v124, v116, v117
  v_cvt_pk_bf16_f32 v125, v118, v119
  v_cvt_pk_bf16_f32 v126, v120, v121
  v_cvt_pk_bf16_f32 v127, v122, v123
  v_add_f32 v159, v159, v116
  v_add_f32 v159, v159, v117
  v_add_f32 v159, v159, v118
  v_add_f32 v159, v159, v119
  v_add_f32 v159, v159, v120
  v_add_f32 v159, v159, v121
  v_add_f32 v159, v159, v122
  v_add_f32 v159, v159, v123
  v_readlane_b32 s30, v161, 0
  v_readlane_b32 s31, v161, 1
  v_readlane_b32 s32, v161, 2
  v_readlane_b32 s33, v161, 3
  s_nop 1
  v_mul_f32 v84, s30, v84
  v_mul_f32 v85, s31, v85
  v_mul_f32 v86, s32, v86
  v_mul_f32 v87, s33, v87
  v_mul_f32 v88, s30, v88
  v_mul_f32 v89, s31, v89
  v_mul_f32 v90, s32, v90
  v_mul_f32 v91, s33, v91
  v_mul_f32 v92, s30, v92
  v_mul_f32 v93, s31, v93
  v_mul_f32 v94, s32, v94
  v_mul_f32 v95, s33, v95
  v_mul_f32 v96, s30, v96
  v_mul_f32 v97, s31, v97
  v_mul_f32 v98, s32, v98
  v_mul_f32 v99, s33, v99
  v_mul_f32 v100, s30, v100
  v_mul_f32 v101, s31, v101
  v_mul_f32 v102, s32, v102
  v_mul_f32 v103, s33, v103
  v_mul_f32 v104, s30, v104
  v_mul_f32 v105, s31, v105
  v_mul_f32 v106, s32, v106
  v_mul_f32 v107, s33, v107
  v_mul_f32 v108, s30, v108
  v_mul_f32 v109, s31, v109
  v_mul_f32 v110, s32, v110
  v_mul_f32 v111, s33, v111
  v_mul_f32 v112, s30, v112
  v_mul_f32 v113, s31, v113
  v_mul_f32 v114, s32, v114
  v_mul_f32 v115, s33, v115
  s_waitcnt lgkmcnt(0)
  v_mfma_f32_16x16x32_bf16 v[84:87], v[124:127], v[128:131], v[84:87]
  v_mfma_f32_16x16x32_bf16 v[88:91], v[124:127], v[132:135], v[88:91]
  v_mfma_f32_16x16x32_bf16 v[92:95], v[124:127], v[136:139], v[92:95]
  v_mfma_f32_16x16x32_bf16 v[96:99], v[124:127], v[140:143], v[96:99]
  ds_read_b64_tr_b16 v[128:129], v148 offset:8192
  ds_read_b64_tr_b16 v[130:131], v148 offset:12288
  ds_read_b64_tr_b16 v[132:133], v149 offset:8192
  ds_read_b64_tr_b16 v[134:135], v149 offset:12288
  ds_read_b64_tr_b16 v[136:137], v150 offset:8192
  ds_read_b64_tr_b16 v[138:139], v150 offset:12288
  ds_read_b64_tr_b16 v[140:141], v151 offset:8192
  ds_read_b64_tr_b16 v[142:143], v151 offset:12288
  s_waitcnt lgkmcnt(0)
  v_mfma_f32_16x16x32_bf16 v[100:103], v[124:127], v[128:131], v[100:103]
  v_mfma_f32_16x16x32_bf16 v[104:107], v[124:127], v[132:135], v[104:107]
  v_mfma_f32_16x16x32_bf16 v[108:111], v[124:127], v[136:139], v[108:111]
  v_mfma_f32_16x16x32_bf16 v[112:115], v[124:127], v[140:143], v[112:115]
  s_nop 7
  global_load_dwordx4 v[52:55], v152, s[20:21] offset:0
  global_load_dwordx4 v[56:59], v152, s[20:21] offset:64
  global_load_dwordx4 v[60:63], v152, s[20:21] offset:128
  global_load_dwordx4 v[64:67], v152, s[20:21] offset:192
  global_load_dwordx4 v[68:71], v153, s[20:21] offset:0
  global_load_dwordx4 v[72:75], v153, s[20:21] offset:64
  global_load_dwordx4 v[76:79], v153, s[20:21] offset:128
  global_load_dwordx4 v[80:83], v153, s[20:21] offset:192
  s_add_u32 s24, s16, 8192
  s_mov_b32 m0, s24
  s_nop 0
  global_load_lds_dwordx4 v154, s[22:23] offset:0 nt
  global_load_lds_dwordx4 v155, s[22:23] offset:1024 nt
  global_load_lds_dwordx4 v154, s[22:23] offset:2048 nt
  global_load_lds_dwordx4 v155, s[22:23] offset:3072 nt
  s_add_u32 s24, s16, 12288
  s_mov_b32 m0, s24
  s_nop 0
  global_load_lds_dwordx4 v156, s[22:23] offset:0 nt
  global_load_lds_dwordx4 v157, s[22:23] offset:1024 nt
  global_load_lds_dwordx4 v156, s[22:23] offset:2048 nt
  global_load_lds_dwordx4 v157, s[22:23] offset:3072 nt
  s_add_u32 s20, s20, 0x10000
  s_addc_u32 s21, s21, 0
  s_add_u32 s22, s22, 0x10000
  s_addc_u32 s23, s23, 0
  s_waitcnt vmcnt(16)
  v_mfma_f32_16x16x32_bf16 v[116:119], v[20:23], v[4:7], 0
  v_mfma_f32_16x16x32_bf16 v[116:119], v[24:27], v[8:11], v[116:119]
  v_mfma_f32_16x16x32_bf16 v[116:119], v[28:31], v[12:15], v[116:119]
  v_mfma_f32_16x16x32_bf16 v[116:119], v[32:35], v[16:19], v[116:119]
  v_mfma_f32_16x16x32_bf16 v[120:123], v[36:39], v[4:7], 0
  v_mfma_f32_16x16x32_bf16 v[120:123], v[40:43], v[8:11], v[120:123]
  v_mfma_f32_16x16x32_bf16 v[120:123], v[44:47], v[12:15], v[120:123]
  v_mfma_f32_16x16x32_bf16 v[120:123], v[48:51], v[16:19], v[120:123]
  ds_read_b64_tr_b16 v[128:129], v144 offset:0
  ds_read_b64_tr_b16 v[130:131], v144 offset:4096
  ds_read_b64_tr_b16 v[132:133], v145 offset:0
  ds_read_b64_tr_b16 v[134:135], v145 offset:4096
  ds_read_b64_tr_b16 v[136:137], v146 offset:0
  ds_read_b64_tr_b16 v[138:139], v146 offset:4096
  ds_read_b64_tr_b16 v[140:141], v147 offset:0
  ds_read_b64_tr_b16 v[142:143], v147 offset:4096
  s_nop 7
  v_cvt_pk_bf16_f32 v160, v116, v116
  v_lshlrev_b32 v116, 16, v160
  v_mul_f32 v116, 0x3db504f3, v116
  v_cvt_pk_bf16_f32 v160, v116, v116
  v_lshlrev_b32 v116, 16, v160
  v_cvt_pk_bf16_f32 v160, v117, v117
  v_lshlrev_b32 v117, 16, v160
  v_mul_f32 v117, 0x3db504f3, v117
  v_cvt_pk_bf16_f32 v160, v117, v117
  v_lshlrev_b32 v117, 16, v160
  v_cvt_pk_bf16_f32 v160, v118, v118
  v_lshlrev_b32 v118, 16, v160
  v_mul_f32 v118, 0x3db504f3, v118
  v_cvt_pk_bf16_f32 v160, v118, v118
  v_lshlrev_b32 v118, 16, v160
  v_cvt_pk_bf16_f32 v160, v119, v119
  v_lshlrev_b32 v119, 16, v160
  v_mul_f32 v119, 0x3db504f3, v119
  v_cvt_pk_bf16_f32 v160, v119, v119
  v_lshlrev_b32 v119, 16, v160
  v_cvt_pk_bf16_f32 v160, v120, v120
  v_lshlrev_b32 v120, 16, v160
  v_mul_f32 v120, 0x3db504f3, v120
  v_cvt_pk_bf16_f32 v160, v120, v120
  v_lshlrev_b32 v120, 16, v160
  v_cvt_pk_bf16_f32 v160, v121, v121
  v_lshlrev_b32 v121, 16, v160
  v_mul_f32 v121, 0x3db504f3, v121
  v_cvt_pk_bf16_f32 v160, v121, v121
  v_lshlrev_b32 v121, 16, v160
  v_cvt_pk_bf16_f32 v160, v122, v122
  v_lshlrev_b32 v122, 16, v160
  v_mul_f32 v122, 0x3db504f3, v122
  v_cvt_pk_bf16_f32 v160, v122, v122
  v_lshlrev_b32 v122, 16, v160
  v_cvt_pk_bf16_f32 v160, v123, v123
  v_lshlrev_b32 v123, 16, v160
  v_mul_f32 v123, 0x3db504f3, v123
  v_cvt_pk_bf16_f32 v160, v123, v123
  v_lshlrev_b32 v123, 16, v160
  v_max3_f32 v160, v116, v117, v118
  v_max3_f32 v160, v119, v120, v160
  v_max3_f32 v160, v121, v122, v160
  v_max_f32 v160, v123, v160
  v_mov_b32 v161, v160
  s_nop 1
  v_permlane16_swap_b32 v160, v161
  v_max_f32 v160, v160, v161
  v_mov_b32 v161, v160
  s_nop 1
  v_permlane32_swap_b32 v160, v161
  v_max_f32 v160, v160, v161
  v_max_f32 v160, v160, v158
  v_sub_f32 v161, v158, v160
  v_mul_f32 v161, 0x3fb8aa3b, v161
  v_exp_f32 v161, v161
  v_mov_b32 v158, v160
  v_sub_f32 v116, v116, v160
  v_mul_f32 v116, 0x3fb8aa3b, v116
  v_exp_f32 v116, v116
  v_sub_f32 v117, v117, v160
  v_mul_f32 v117, 0x3fb8aa3b, v117
  v_exp_f32 v117, v117
  v_sub_f32 v118, v118, v160
  v_mul_f32 v118, 0x3fb8aa3b, v118
  v_exp_f32 v118, v118
  v_sub_f32 v119, v119, v160
  v_mul_f32 v119, 0x3fb8aa3b, v119
  v_exp_f32 v119, v119
  v_sub_f32 v120, v120, v160
  v_mul_f32 v120, 0x3fb8aa3b, v120
  v_exp_f32 v120, v120
  v_sub_f32 v121, v121, v160
  v_mul_f32 v121, 0x3fb8aa3b, v121
  v_exp_f32 v121, v121
  v_sub_f32 v122, v122, v160
  v_mul_f32 v122, 0x3fb8aa3b, v122
  v_exp_f32 v122, v122
  v_sub_f32 v123, v123, v160
  v_mul_f32 v123, 0x3fb8aa3b, v123
  v_exp_f32 v123, v123
  v_mul_f32 v159, v159, v161
  v_cvt_pk_bf16_f32 v124, v116, v117
  v_cvt_pk_bf16_f32 v125, v118, v119
  v_cvt_pk_bf16_f32 v126, v120, v121
  v_cvt_pk_bf16_f32 v127, v122, v123
  v_add_f32 v159, v159, v116
  v_add_f32 v159, v159, v117
  v_add_f32 v159, v159, v118
  v_add_f32 v159, v159, v119
  v_add_f32 v159, v159, v120
  v_add_f32 v159, v159, v121
  v_add_f32 v159, v159, v122
  v_add_f32 v159, v159, v123
  v_readlane_b32 s30, v161, 0
  v_readlane_b32 s31, v161, 1
  v_readlane_b32 s32, v161, 2
  v_readlane_b32 s33, v161, 3
  s_nop 1
  v_mul_f32 v84, s30, v84
  v_mul_f32 v85, s31, v85
  v_mul_f32 v86, s32, v86
  v_mul_f32 v87, s33, v87
  v_mul_f32 v88, s30, v88
  v_mul_f32 v89, s31, v89
  v_mul_f32 v90, s32, v90
  v_mul_f32 v91, s33, v91
  v_mul_f32 v92, s30, v92
  v_mul_f32 v93, s31, v93
  v_mul_f32 v94, s32, v94
  v_mul_f32 v95, s33, v95
  v_mul_f32 v96, s30, v96
  v_mul_f32 v97, s31, v97
  v_mul_f32 v98, s32, v98
  v_mul_f32 v99, s33, v99
  v_mul_f32 v100, s30, v100
  v_mul_f32 v101, s31, v101
  v_mul_f32 v102, s32, v102
  v_mul_f32 v103, s33, v103
  v_mul_f32 v104, s30, v104
  v_mul_f32 v105, s31, v105
  v_mul_f32 v106, s32, v106
  v_mul_f32 v107, s33, v107
  v_mul_f32 v108, s30, v108
  v_mul_f32 v109, s31, v109
  v_mul_f32 v110, s32, v110
  v_mul_f32 v111, s33, v111
  v_mul_f32 v112, s30, v112
  v_mul_f32 v113, s31, v113
  v_mul_f32 v114, s32, v114
  v_mul_f32 v115, s33, v115
  s_waitcnt lgkmcnt(0)
  v_mfma_f32_16x16x32_bf16 v[84:87], v[124:127], v[128:131], v[84:87]
  v_mfma_f32_16x16x32_bf16 v[88:91], v[124:127], v[132:135], v[88:91]
  v_mfma_f32_16x16x32_bf16 v[92:95], v[124:127], v[136:139], v[92:95]
  v_mfma_f32_16x16x32_bf16 v[96:99], v[124:127], v[140:143], v[96:99]
  ds_read_b64_tr_b16 v[128:129], v148 offset:0
  ds_read_b64_tr_b16 v[130:131], v148 offset:4096
  ds_read_b64_tr_b16 v[132:133], v149 offset:0
  ds_read_b64_tr_b16 v[134:135], v149 offset:4096
  ds_read_b64_tr_b16 v[136:137], v150 offset:0
  ds_read_b64_tr_b16 v[138:139], v150 offset:4096
  ds_read_b64_tr_b16 v[140:141], v151 offset:0
  ds_read_b64_tr_b16 v[142:143], v151 offset:4096
  s_waitcnt lgkmcnt(0)
  v_mfma_f32_16x16x32_bf16 v[100:103], v[124:127], v[128:131], v[100:103]
  v_mfma_f32_16x16x32_bf16 v[104:107], v[124:127], v[132:135], v[104:107]
  v_mfma_f32_16x16x32_bf16 v[108:111], v[124:127], v[136:139], v[108:111]
  v_mfma_f32_16x16x32_bf16 v[112:115], v[124:127], v[140:143], v[112:115]
  s_nop 7
  global_load_dwordx4 v[20:23], v152, s[20:21] offset:0
  global_load_dwordx4 v[24:27], v152, s[20:21] offset:64
  global_load_dwordx4 v[28:31], v152, s[20:21] offset:128
  global_load_dwordx4 v[32:35], v152, s[20:21] offset:192
  global_load_dwordx4 v[36:39], v153, s[20:21] offset:0
  global_load_dwordx4 v[40:43], v153, s[20:21] offset:64
  global_load_dwordx4 v[44:47], v153, s[20:21] offset:128
  global_load_dwordx4 v[48:51], v153, s[20:21] offset:192
  s_add_u32 s24, s16, 0
  s_mov_b32 m0, s24
  s_nop 0
  global_load_lds_dwordx4 v154, s[22:23] offset:0 nt
  global_load_lds_dwordx4 v155, s[22:23] offset:1024 nt
  global_load_lds_dwordx4 v154, s[22:23] offset:2048 nt
  global_load_lds_dwordx4 v155, s[22:23] offset:3072 nt
  s_add_u32 s24, s16, 4096
  s_mov_b32 m0, s24
  s_nop 0
  global_load_lds_dwordx4 v156, s[22:23] offset:0 nt
  global_load_lds_dwordx4 v157, s[22:23] offset:1024 nt
  global_load_lds_dwordx4 v156, s[22:23] offset:2048 nt
  global_load_lds_dwordx4 v157, s[22:23] offset:3072 nt
  s_add_u32 s20, s20, 0x10000
  s_addc_u32 s21, s21, 0
  s_add_u32 s22, s22, 0x10000
  s_addc_u32 s23, s23, 0
  s_waitcnt vmcnt(16)
  v_mfma_f32_16x16x32_bf16 v[116:119], v[52:55], v[4:7], 0
  v_mfma_f32_16x16x32_bf16 v[116:119], v[56:59], v[8:11], v[116:119]
  v_mfma_f32_16x16x32_bf16 v[116:119], v[60:63], v[12:15], v[116:119]
  v_mfma_f32_16x16x32_bf16 v[116:119], v[64:67], v[16:19], v[116:119]
  v_mfma_f32_16x16x32_bf16 v[120:123], v[68:71], v[4:7], 0
  v_mfma_f32_16x16x32_bf16 v[120:123], v[72:75], v[8:11], v[120:123]
  v_mfma_f32_16x16x32_bf16 v[120:123], v[76:79], v[12:15], v[120:123]
  v_mfma_f32_16x16x32_bf16 v[120:123], v[80:83], v[16:19], v[120:123]
  ds_read_b64_tr_b16 v[128:129], v144 offset:8192
  ds_read_b64_tr_b16 v[130:131], v144 offset:12288
  ds_read_b64_tr_b16 v[132:133], v145 offset:8192
  ds_read_b64_tr_b16 v[134:135], v145 offset:12288
  ds_read_b64_tr_b16 v[136:137], v146 offset:8192
  ds_read_b64_tr_b16 v[138:139], v146 offset:12288
  ds_read_b64_tr_b16 v[140:141], v147 offset:8192
  ds_read_b64_tr_b16 v[142:143], v147 offset:12288
  s_nop 7
  v_cvt_pk_bf16_f32 v160, v116, v116
  v_lshlrev_b32 v116, 16, v160
  v_mul_f32 v116, 0x3db504f3, v116
  v_cvt_pk_bf16_f32 v160, v116, v116
  v_lshlrev_b32 v116, 16, v160
  v_cvt_pk_bf16_f32 v160, v117, v117
  v_lshlrev_b32 v117, 16, v160
  v_mul_f32 v117, 0x3db504f3, v117
  v_cvt_pk_bf16_f32 v160, v117, v117
  v_lshlrev_b32 v117, 16, v160
  v_cvt_pk_bf16_f32 v160, v118, v118
  v_lshlrev_b32 v118, 16, v160
  v_mul_f32 v118, 0x3db504f3, v118
  v_cvt_pk_bf16_f32 v160, v118, v118
  v_lshlrev_b32 v118, 16, v160
  v_cvt_pk_bf16_f32 v160, v119, v119
  v_lshlrev_b32 v119, 16, v160
  v_mul_f32 v119, 0x3db504f3, v119
  v_cvt_pk_bf16_f32 v160, v119, v119
  v_lshlrev_b32 v119, 16, v160
  v_cvt_pk_bf16_f32 v160, v120, v120
  v_lshlrev_b32 v120, 16, v160
  v_mul_f32 v120, 0x3db504f3, v120
  v_cvt_pk_bf16_f32 v160, v120, v120
  v_lshlrev_b32 v120, 16, v160
  v_cvt_pk_bf16_f32 v160, v121, v121
  v_lshlrev_b32 v121, 16, v160
  v_mul_f32 v121, 0x3db504f3, v121
  v_cvt_pk_bf16_f32 v160, v121, v121
  v_lshlrev_b32 v121, 16, v160
  v_cvt_pk_bf16_f32 v160, v122, v122
  v_lshlrev_b32 v122, 16, v160
  v_mul_f32 v122, 0x3db504f3, v122
  v_cvt_pk_bf16_f32 v160, v122, v122
  v_lshlrev_b32 v122, 16, v160
  v_cvt_pk_bf16_f32 v160, v123, v123
  v_lshlrev_b32 v123, 16, v160
  v_mul_f32 v123, 0x3db504f3, v123
  v_cvt_pk_bf16_f32 v160, v123, v123
  v_lshlrev_b32 v123, 16, v160
  v_max3_f32 v160, v116, v117, v118
  v_max3_f32 v160, v119, v120, v160
  v_max3_f32 v160, v121, v122, v160
  v_max_f32 v160, v123, v160
  v_mov_b32 v161, v160
  s_nop 1
  v_permlane16_swap_b32 v160, v161
  v_max_f32 v160, v160, v161
  v_mov_b32 v161, v160
  s_nop 1
  v_permlane32_swap_b32 v160, v161
  v_max_f32 v160, v160, v161
  v_max_f32 v160, v160, v158
  v_sub_f32 v161, v158, v160
  v_mul_f32 v161, 0x3fb8aa3b, v161
  v_exp_f32 v161, v161
  v_mov_b32 v158, v160
  v_sub_f32 v116, v116, v160
  v_mul_f32 v116, 0x3fb8aa3b, v116
  v_exp_f32 v116, v116
  v_sub_f32 v117, v117, v160
  v_mul_f32 v117, 0x3fb8aa3b, v117
  v_exp_f32 v117, v117
  v_sub_f32 v118, v118, v160
  v_mul_f32 v118, 0x3fb8aa3b, v118
  v_exp_f32 v118, v118
  v_sub_f32 v119, v119, v160
  v_mul_f32 v119, 0x3fb8aa3b, v119
  v_exp_f32 v119, v119
  v_sub_f32 v120, v120, v160
  v_mul_f32 v120, 0x3fb8aa3b, v120
  v_exp_f32 v120, v120
  v_sub_f32 v121, v121, v160
  v_mul_f32 v121, 0x3fb8aa3b, v121
  v_exp_f32 v121, v121
  v_sub_f32 v122, v122, v160
  v_mul_f32 v122, 0x3fb8aa3b, v122
  v_exp_f32 v122, v122
  v_sub_f32 v123, v123, v160
  v_mul_f32 v123, 0x3fb8aa3b, v123
  v_exp_f32 v123, v123
  v_mul_f32 v159, v159, v161
  v_cvt_pk_bf16_f32 v124, v116, v117
  v_cvt_pk_bf16_f32 v125, v118, v119
  v_cvt_pk_bf16_f32 v126, v120, v121
  v_cvt_pk_bf16_f32 v127, v122, v123
  v_add_f32 v159, v159, v116
  v_add_f32 v159, v159, v117
  v_add_f32 v159, v159, v118
  v_add_f32 v159, v159, v119
  v_add_f32 v159, v159, v120
  v_add_f32 v159, v159, v121
  v_add_f32 v159, v159, v122
  v_add_f32 v159, v159, v123
  v_readlane_b32 s30, v161, 0
  v_readlane_b32 s31, v161, 1
  v_readlane_b32 s32, v161, 2
  v_readlane_b32 s33, v161, 3
  s_nop 1
  v_mul_f32 v84, s30, v84
  v_mul_f32 v85, s31, v85
  v_mul_f32 v86, s32, v86
  v_mul_f32 v87, s33, v87
  v_mul_f32 v88, s30, v88
  v_mul_f32 v89, s31, v89
  v_mul_f32 v90, s32, v90
  v_mul_f32 v91, s33, v91
  v_mul_f32 v92, s30, v92
  v_mul_f32 v93, s31, v93
  v_mul_f32 v94, s32, v94
  v_mul_f32 v95, s33, v95
  v_mul_f32 v96, s30, v96
  v_mul_f32 v97, s31, v97
  v_mul_f32 v98, s32, v98
  v_mul_f32 v99, s33, v99
  v_mul_f32 v100, s30, v100
  v_mul_f32 v101, s31, v101
  v_mul_f32 v102, s32, v102
  v_mul_f32 v103, s33, v103
  v_mul_f32 v104, s30, v104
  v_mul_f32 v105, s31, v105
  v_mul_f32 v106, s32, v106
  v_mul_f32 v107, s33, v107
  v_mul_f32 v108, s30, v108
  v_mul_f32 v109, s31, v109
  v_mul_f32 v110, s32, v110
  v_mul_f32 v111, s33, v111
  v_mul_f32 v112, s30, v112
  v_mul_f32 v113, s31, v113
  v_mul_f32 v114, s32, v114
  v_mul_f32 v115, s33, v115
  s_waitcnt lgkmcnt(0)
  v_mfma_f32_16x16x32_bf16 v[84:87], v[124:127], v[128:131], v[84:87]
  v_mfma_f32_16x16x32_bf16 v[88:91], v[124:127], v[132:135], v[88:91]
  v_mfma_f32_16x16x32_bf16 v[92:95], v[124:127], v[136:139], v[92:95]
  v_mfma_f32_16x16x32_bf16 v[96:99], v[124:127], v[140:143], v[96:99]
  ds_read_b64_tr_b16 v[128:129], v148 offset:8192
  ds_read_b64_tr_b16 v[130:131], v148 offset:12288
  ds_read_b64_tr_b16 v[132:133], v149 offset:8192
  ds_read_b64_tr_b16 v[134:135], v149 offset:12288
  ds_read_b64_tr_b16 v[136:137], v150 offset:8192
  ds_read_b64_tr_b16 v[138:139], v150 offset:12288
  ds_read_b64_tr_b16 v[140:141], v151 offset:8192
  ds_read_b64_tr_b16 v[142:143], v151 offset:12288
  s_waitcnt lgkmcnt(0)
  v_mfma_f32_16x16x32_bf16 v[100:103], v[124:127], v[128:131], v[100:103]
  v_mfma_f32_16x16x32_bf16 v[104:107], v[124:127], v[132:135], v[104:107]
  v_mfma_f32_16x16x32_bf16 v[108:111], v[124:127], v[136:139], v[108:111]
  v_mfma_f32_16x16x32_bf16 v[112:115], v[124:127], v[140:143], v[112:115]
  s_nop 7
  global_load_dwordx4 v[52:55], v152, s[20:21] offset:0
  global_load_dwordx4 v[56:59], v152, s[20:21] offset:64
  global_load_dwordx4 v[60:63], v152, s[20:21] offset:128
  global_load_dwordx4 v[64:67], v152, s[20:21] offset:192
  global_load_dwordx4 v[68:71], v153, s[20:21] offset:0
  global_load_dwordx4 v[72:75], v153, s[20:21] offset:64
  global_load_dwordx4 v[76:79], v153, s[20:21] offset:128
  global_load_dwordx4 v[80:83], v153, s[20:21] offset:192
  s_add_u32 s24, s16, 8192
  s_mov_b32 m0, s24
  s_nop 0
  global_load_lds_dwordx4 v154, s[22:23] offset:0 nt
  global_load_lds_dwordx4 v155, s[22:23] offset:1024 nt
  global_load_lds_dwordx4 v154, s[22:23] offset:2048 nt
  global_load_lds_dwordx4 v155, s[22:23] offset:3072 nt
  s_add_u32 s24, s16, 12288
  s_mov_b32 m0, s24
  s_nop 0
  global_load_lds_dwordx4 v156, s[22:23] offset:0 nt
  global_load_lds_dwordx4 v157, s[22:23] offset:1024 nt
  global_load_lds_dwordx4 v156, s[22:23] offset:2048 nt
  global_load_lds_dwordx4 v157, s[22:23] offset:3072 nt
  s_add_u32 s20, s20, 0x10000
  s_addc_u32 s21, s21, 0
  s_add_u32 s22, s22, 0x10000
  s_addc_u32 s23, s23, 0
  s_waitcnt vmcnt(16)
  v_mfma_f32_16x16x32_bf16 v[116:119], v[20:23], v[4:7], 0
  v_mfma_f32_16x16x32_bf16 v[116:119], v[24:27], v[8:11], v[116:119]
  v_mfma_f32_16x16x32_bf16 v[116:119], v[28:31], v[12:15], v[116:119]
  v_mfma_f32_16x16x32_bf16 v[116:119], v[32:35], v[16:19], v[116:119]
  v_mfma_f32_16x16x32_bf16 v[120:123], v[36:39], v[4:7], 0
  v_mfma_f32_16x16x32_bf16 v[120:123], v[40:43], v[8:11], v[120:123]
  v_mfma_f32_16x16x32_bf16 v[120:123], v[44:47], v[12:15], v[120:123]
  v_mfma_f32_16x16x32_bf16 v[120:123], v[48:51], v[16:19], v[120:123]
  ds_read_b64_tr_b16 v[128:129], v144 offset:0
  ds_read_b64_tr_b16 v[130:131], v144 offset:4096
  ds_read_b64_tr_b16 v[132:133], v145 offset:0
  ds_read_b64_tr_b16 v[134:135], v145 offset:4096
  ds_read_b64_tr_b16 v[136:137], v146 offset:0
  ds_read_b64_tr_b16 v[138:139], v146 offset:4096
  ds_read_b64_tr_b16 v[140:141], v147 offset:0
  ds_read_b64_tr_b16 v[142:143], v147 offset:4096
  s_nop 7
  v_cvt_pk_bf16_f32 v160, v116, v116
  v_lshlrev_b32 v116, 16, v160
  v_mul_f32 v116, 0x3db504f3, v116
  v_cvt_pk_bf16_f32 v160, v116, v116
  v_lshlrev_b32 v116, 16, v160
  v_cvt_pk_bf16_f32 v160, v117, v117
  v_lshlrev_b32 v117, 16, v160
  v_mul_f32 v117, 0x3db504f3, v117
  v_cvt_pk_bf16_f32 v160, v117, v117
  v_lshlrev_b32 v117, 16, v160
  v_cvt_pk_bf16_f32 v160, v118, v118
  v_lshlrev_b32 v118, 16, v160
  v_mul_f32 v118, 0x3db504f3, v118
  v_cvt_pk_bf16_f32 v160, v118, v118
  v_lshlrev_b32 v118, 16, v160
  v_cvt_pk_bf16_f32 v160, v119, v119
  v_lshlrev_b32 v119, 16, v160
  v_mul_f32 v119, 0x3db504f3, v119
  v_cvt_pk_bf16_f32 v160, v119, v119
  v_lshlrev_b32 v119, 16, v160
  v_cvt_pk_bf16_f32 v160, v120, v120
  v_lshlrev_b32 v120, 16, v160
  v_mul_f32 v120, 0x3db504f3, v120
  v_cvt_pk_bf16_f32 v160, v120, v120
  v_lshlrev_b32 v120, 16, v160
  v_cvt_pk_bf16_f32 v160, v121, v121
  v_lshlrev_b32 v121, 16, v160
  v_mul_f32 v121, 0x3db504f3, v121
  v_cvt_pk_bf16_f32 v160, v121, v121
  v_lshlrev_b32 v121, 16, v160
  v_cvt_pk_bf16_f32 v160, v122, v122
  v_lshlrev_b32 v122, 16, v160
  v_mul_f32 v122, 0x3db504f3, v122
  v_cvt_pk_bf16_f32 v160, v122, v122
  v_lshlrev_b32 v122, 16, v160
  v_cvt_pk_bf16_f32 v160, v123, v123
  v_lshlrev_b32 v123, 16, v160
  v_mul_f32 v123, 0x3db504f3, v123
  v_cvt_pk_bf16_f32 v160, v123, v123
  v_lshlrev_b32 v123, 16, v160
  v_max3_f32 v160, v116, v117, v118
  v_max3_f32 v160, v119, v120, v160
  v_max3_f32 v160, v121, v122, v160
  v_max_f32 v160, v123, v160
  v_mov_b32 v161, v160
  s_nop 1
  v_permlane16_swap_b32 v160, v161
  v_max_f32 v160, v160, v161
  v_mov_b32 v161, v160
  s_nop 1
  v_permlane32_swap_b32 v160, v161
  v_max_f32 v160, v160, v161
  v_max_f32 v160, v160, v158
  v_sub_f32 v161, v158, v160
  v_mul_f32 v161, 0x3fb8aa3b, v161
  v_exp_f32 v161, v161
  v_mov_b32 v158, v160
  v_sub_f32 v116, v116, v160
  v_mul_f32 v116, 0x3fb8aa3b, v116
  v_exp_f32 v116, v116
  v_sub_f32 v117, v117, v160
  v_mul_f32 v117, 0x3fb8aa3b, v117
  v_exp_f32 v117, v117
  v_sub_f32 v118, v118, v160
  v_mul_f32 v118, 0x3fb8aa3b, v118
  v_exp_f32 v118, v118
  v_sub_f32 v119, v119, v160
  v_mul_f32 v119, 0x3fb8aa3b, v119
  v_exp_f32 v119, v119
  v_sub_f32 v120, v120, v160
  v_mul_f32 v120, 0x3fb8aa3b, v120
  v_exp_f32 v120, v120
  v_sub_f32 v121, v121, v160
  v_mul_f32 v121, 0x3fb8aa3b, v121
  v_exp_f32 v121, v121
  v_sub_f32 v122, v122, v160
  v_mul_f32 v122, 0x3fb8aa3b, v122
  v_exp_f32 v122, v122
  v_sub_f32 v123, v123, v160
  v_mul_f32 v123, 0x3fb8aa3b, v123
  v_exp_f32 v123, v123
  v_mul_f32 v159, v159, v161
  v_cvt_pk_bf16_f32 v124, v116, v117
  v_cvt_pk_bf16_f32 v125, v118, v119
  v_cvt_pk_bf16_f32 v126, v120, v121
  v_cvt_pk_bf16_f32 v127, v122, v123
  v_add_f32 v159, v159, v116
  v_add_f32 v159, v159, v117
  v_add_f32 v159, v159, v118
  v_add_f32 v159, v159, v119
  v_add_f32 v159, v159, v120
  v_add_f32 v159, v159, v121
  v_add_f32 v159, v159, v122
  v_add_f32 v159, v159, v123
  v_readlane_b32 s30, v161, 0
  v_readlane_b32 s31, v161, 1
  v_readlane_b32 s32, v161, 2
  v_readlane_b32 s33, v161, 3
  s_nop 1
  v_mul_f32 v84, s30, v84
  v_mul_f32 v85, s31, v85
  v_mul_f32 v86, s32, v86
  v_mul_f32 v87, s33, v87
  v_mul_f32 v88, s30, v88
  v_mul_f32 v89, s31, v89
  v_mul_f32 v90, s32, v90
  v_mul_f32 v91, s33, v91
  v_mul_f32 v92, s30, v92
  v_mul_f32 v93, s31, v93
  v_mul_f32 v94, s32, v94
  v_mul_f32 v95, s33, v95
  v_mul_f32 v96, s30, v96
  v_mul_f32 v97, s31, v97
  v_mul_f32 v98, s32, v98
  v_mul_f32 v99, s33, v99
  v_mul_f32 v100, s30, v100
  v_mul_f32 v101, s31, v101
  v_mul_f32 v102, s32, v102
  v_mul_f32 v103, s33, v103
  v_mul_f32 v104, s30, v104
  v_mul_f32 v105, s31, v105
  v_mul_f32 v106, s32, v106
  v_mul_f32 v107, s33, v107
  v_mul_f32 v108, s30, v108
  v_mul_f32 v109, s31, v109
  v_mul_f32 v110, s32, v110
  v_mul_f32 v111, s33, v111
  v_mul_f32 v112, s30, v112
  v_mul_f32 v113, s31, v113
  v_mul_f32 v114, s32, v114
  v_mul_f32 v115, s33, v115
  s_waitcnt lgkmcnt(0)
  v_mfma_f32_16x16x32_bf16 v[84:87], v[124:127], v[128:131], v[84:87]
  v_mfma_f32_16x16x32_bf16 v[88:91], v[124:127], v[132:135], v[88:91]
  v_mfma_f32_16x16x32_bf16 v[92:95], v[124:127], v[136:139], v[92:95]
  v_mfma_f32_16x16x32_bf16 v[96:99], v[124:127], v[140:143], v[96:99]
  ds_read_b64_tr_b16 v[128:129], v148 offset:0
  ds_read_b64_tr_b16 v[130:131], v148 offset:4096
  ds_read_b64_tr_b16 v[132:133], v149 offset:0
  ds_read_b64_tr_b16 v[134:135], v149 offset:4096
  ds_read_b64_tr_b16 v[136:137], v150 offset:0
  ds_read_b64_tr_b16 v[138:139], v150 offset:4096
  ds_read_b64_tr_b16 v[140:141], v151 offset:0
  ds_read_b64_tr_b16 v[142:143], v151 offset:4096
  s_waitcnt lgkmcnt(0)
  v_mfma_f32_16x16x32_bf16 v[100:103], v[124:127], v[128:131], v[100:103]
  v_mfma_f32_16x16x32_bf16 v[104:107], v[124:127], v[132:135], v[104:107]
  v_mfma_f32_16x16x32_bf16 v[108:111], v[124:127], v[136:139], v[108:111]
  v_mfma_f32_16x16x32_bf16 v[112:115], v[124:127], v[140:143], v[112:115]
  s_nop 7
  global_load_dwordx4 v[20:23], v152, s[20:21] offset:0
  global_load_dwordx4 v[24:27], v152, s[20:21] offset:64
  global_load_dwordx4 v[28:31], v152, s[20:21] offset:128
  global_load_dwordx4 v[32:35], v152, s[20:21] offset:192
  global_load_dwordx4 v[36:39], v153, s[20:21] offset:0
  global_load_dwordx4 v[40:43], v153, s[20:21] offset:64
  global_load_dwordx4 v[44:47], v153, s[20:21] offset:128
  global_load_dwordx4 v[48:51], v153, s[20:21] offset:192
  s_add_u32 s24, s16, 0
  s_mov_b32 m0, s24
  s_nop 0
  global_load_lds_dwordx4 v154, s[22:23] offset:0 nt
  global_load_lds_dwordx4 v155, s[22:23] offset:1024 nt
  global_load_lds_dwordx4 v154, s[22:23] offset:2048 nt
  global_load_lds_dwordx4 v155, s[22:23] offset:3072 nt
  s_add_u32 s24, s16, 4096
  s_mov_b32 m0, s24
  s_nop 0
  global_load_lds_dwordx4 v156, s[22:23] offset:0 nt
  global_load_lds_dwordx4 v157, s[22:23] offset:1024 nt
  global_load_lds_dwordx4 v156, s[22:23] offset:2048 nt
  global_load_lds_dwordx4 v157, s[22:23] offset:3072 nt
  s_add_u32 s20, s20, 0x10000
  s_addc_u32 s21, s21, 0
  s_add_u32 s22, s22, 0x10000
  s_addc_u32 s23, s23, 0
  s_waitcnt vmcnt(16)
  v_mfma_f32_16x16x32_bf16 v[116:119], v[52:55], v[4:7], 0
  v_mfma_f32_16x16x32_bf16 v[116:119], v[56:59], v[8:11], v[116:119]
  v_mfma_f32_16x16x32_bf16 v[116:119], v[60:63], v[12:15], v[116:119]
  v_mfma_f32_16x16x32_bf16 v[116:119], v[64:67], v[16:19], v[116:119]
  v_mfma_f32_16x16x32_bf16 v[120:123], v[68:71], v[4:7], 0
  v_mfma_f32_16x16x32_bf16 v[120:123], v[72:75], v[8:11], v[120:123]
  v_mfma_f32_16x16x32_bf16 v[120:123], v[76:79], v[12:15], v[120:123]
  v_mfma_f32_16x16x32_bf16 v[120:123], v[80:83], v[16:19], v[120:123]
  ds_read_b64_tr_b16 v[128:129], v144 offset:8192
  ds_read_b64_tr_b16 v[130:131], v144 offset:12288
  ds_read_b64_tr_b16 v[132:133], v145 offset:8192
  ds_read_b64_tr_b16 v[134:135], v145 offset:12288
  ds_read_b64_tr_b16 v[136:137], v146 offset:8192
  ds_read_b64_tr_b16 v[138:139], v146 offset:12288
  ds_read_b64_tr_b16 v[140:141], v147 offset:8192
  ds_read_b64_tr_b16 v[142:143], v147 offset:12288
  s_nop 7
  v_cvt_pk_bf16_f32 v160, v116, v116
  v_lshlrev_b32 v116, 16, v160
  v_mul_f32 v116, 0x3db504f3, v116
  v_cvt_pk_bf16_f32 v160, v116, v116
  v_lshlrev_b32 v116, 16, v160
  v_cvt_pk_bf16_f32 v160, v117, v117
  v_lshlrev_b32 v117, 16, v160
  v_mul_f32 v117, 0x3db504f3, v117
  v_cvt_pk_bf16_f32 v160, v117, v117
  v_lshlrev_b32 v117, 16, v160
  v_cvt_pk_bf16_f32 v160, v118, v118
  v_lshlrev_b32 v118, 16, v160
  v_mul_f32 v118, 0x3db504f3, v118
  v_cvt_pk_bf16_f32 v160, v118, v118
  v_lshlrev_b32 v118, 16, v160
  v_cvt_pk_bf16_f32 v160, v119, v119
  v_lshlrev_b32 v119, 16, v160
  v_mul_f32 v119, 0x3db504f3, v119
  v_cvt_pk_bf16_f32 v160, v119, v119
  v_lshlrev_b32 v119, 16, v160
  v_cvt_pk_bf16_f32 v160, v120, v120
  v_lshlrev_b32 v120, 16, v160
  v_mul_f32 v120, 0x3db504f3, v120
  v_cvt_pk_bf16_f32 v160, v120, v120
  v_lshlrev_b32 v120, 16, v160
  v_cvt_pk_bf16_f32 v160, v121, v121
  v_lshlrev_b32 v121, 16, v160
  v_mul_f32 v121, 0x3db504f3, v121
  v_cvt_pk_bf16_f32 v160, v121, v121
  v_lshlrev_b32 v121, 16, v160
  v_cvt_pk_bf16_f32 v160, v122, v122
  v_lshlrev_b32 v122, 16, v160
  v_mul_f32 v122, 0x3db504f3, v122
  v_cvt_pk_bf16_f32 v160, v122, v122
  v_lshlrev_b32 v122, 16, v160
  v_cvt_pk_bf16_f32 v160, v123, v123
  v_lshlrev_b32 v123, 16, v160
  v_mul_f32 v123, 0x3db504f3, v123
  v_cvt_pk_bf16_f32 v160, v123, v123
  v_lshlrev_b32 v123, 16, v160
  v_max3_f32 v160, v116, v117, v118
  v_max3_f32 v160, v119, v120, v160
  v_max3_f32 v160, v121, v122, v160
  v_max_f32 v160, v123, v160
  v_mov_b32 v161, v160
  s_nop 1
  v_permlane16_swap_b32 v160, v161
  v_max_f32 v160, v160, v161
  v_mov_b32 v161, v160
  s_nop 1
  v_permlane32_swap_b32 v160, v161
  v_max_f32 v160, v160, v161
  v_max_f32 v160, v160, v158
  v_sub_f32 v161, v158, v160
  v_mul_f32 v161, 0x3fb8aa3b, v161
  v_exp_f32 v161, v161
  v_mov_b32 v158, v160
  v_sub_f32 v116, v116, v160
  v_mul_f32 v116, 0x3fb8aa3b, v116
  v_exp_f32 v116, v116
  v_sub_f32 v117, v117, v160
  v_mul_f32 v117, 0x3fb8aa3b, v117
  v_exp_f32 v117, v117
  v_sub_f32 v118, v118, v160
  v_mul_f32 v118, 0x3fb8aa3b, v118
  v_exp_f32 v118, v118
  v_sub_f32 v119, v119, v160
  v_mul_f32 v119, 0x3fb8aa3b, v119
  v_exp_f32 v119, v119
  v_sub_f32 v120, v120, v160
  v_mul_f32 v120, 0x3fb8aa3b, v120
  v_exp_f32 v120, v120
  v_sub_f32 v121, v121, v160
  v_mul_f32 v121, 0x3fb8aa3b, v121
  v_exp_f32 v121, v121
  v_sub_f32 v122, v122, v160
  v_mul_f32 v122, 0x3fb8aa3b, v122
  v_exp_f32 v122, v122
  v_sub_f32 v123, v123, v160
  v_mul_f32 v123, 0x3fb8aa3b, v123
  v_exp_f32 v123, v123
  v_mul_f32 v159, v159, v161
  v_cvt_pk_bf16_f32 v124, v116, v117
  v_cvt_pk_bf16_f32 v125, v118, v119
  v_cvt_pk_bf16_f32 v126, v120, v121
  v_cvt_pk_bf16_f32 v127, v122, v123
  v_add_f32 v159, v159, v116
  v_add_f32 v159, v159, v117
  v_add_f32 v159, v159, v118
  v_add_f32 v159, v159, v119
  v_add_f32 v159, v159, v120
  v_add_f32 v159, v159, v121
  v_add_f32 v159, v159, v122
  v_add_f32 v159, v159, v123
  v_readlane_b32 s30, v161, 0
  v_readlane_b32 s31, v161, 1
  v_readlane_b32 s32, v161, 2
  v_readlane_b32 s33, v161, 3
  s_nop 1
  v_mul_f32 v84, s30, v84
  v_mul_f32 v85, s31, v85
  v_mul_f32 v86, s32, v86
  v_mul_f32 v87, s33, v87
  v_mul_f32 v88, s30, v88
  v_mul_f32 v89, s31, v89
  v_mul_f32 v90, s32, v90
  v_mul_f32 v91, s33, v91
  v_mul_f32 v92, s30, v92
  v_mul_f32 v93, s31, v93
  v_mul_f32 v94, s32, v94
  v_mul_f32 v95, s33, v95
  v_mul_f32 v96, s30, v96
  v_mul_f32 v97, s31, v97
  v_mul_f32 v98, s32, v98
  v_mul_f32 v99, s33, v99
  v_mul_f32 v100, s30, v100
  v_mul_f32 v101, s31, v101
  v_mul_f32 v102, s32, v102
  v_mul_f32 v103, s33, v103
  v_mul_f32 v104, s30, v104
  v_mul_f32 v105, s31, v105
  v_mul_f32 v106, s32, v106
  v_mul_f32 v107, s33, v107
  v_mul_f32 v108, s30, v108
  v_mul_f32 v109, s31, v109
  v_mul_f32 v110, s32, v110
  v_mul_f32 v111, s33, v111
  v_mul_f32 v112, s30, v112
  v_mul_f32 v113, s31, v113
  v_mul_f32 v114, s32, v114
  v_mul_f32 v115, s33, v115
  s_waitcnt lgkmcnt(0)
  v_mfma_f32_16x16x32_bf16 v[84:87], v[124:127], v[128:131], v[84:87]
  v_mfma_f32_16x16x32_bf16 v[88:91], v[124:127], v[132:135], v[88:91]
  v_mfma_f32_16x16x32_bf16 v[92:95], v[124:127], v[136:139], v[92:95]
  v_mfma_f32_16x16x32_bf16 v[96:99], v[124:127], v[140:143], v[96:99]
  ds_read_b64_tr_b16 v[128:129], v148 offset:8192
  ds_read_b64_tr_b16 v[130:131], v148 offset:12288
  ds_read_b64_tr_b16 v[132:133], v149 offset:8192
  ds_read_b64_tr_b16 v[134:135], v149 offset:12288
  ds_read_b64_tr_b16 v[136:137], v150 offset:8192
  ds_read_b64_tr_b16 v[138:139], v150 offset:12288
  ds_read_b64_tr_b16 v[140:141], v151 offset:8192
  ds_read_b64_tr_b16 v[142:143], v151 offset:12288
  s_waitcnt lgkmcnt(0)
  v_mfma_f32_16x16x32_bf16 v[100:103], v[124:127], v[128:131], v[100:103]
  v_mfma_f32_16x16x32_bf16 v[104:107], v[124:127], v[132:135], v[104:107]
  v_mfma_f32_16x16x32_bf16 v[108:111], v[124:127], v[136:139], v[108:111]
  v_mfma_f32_16x16x32_bf16 v[112:115], v[124:127], v[140:143], v[112:115]
  s_nop 7
  global_load_dwordx4 v[52:55], v152, s[20:21] offset:0
  global_load_dwordx4 v[56:59], v152, s[20:21] offset:64
  global_load_dwordx4 v[60:63], v152, s[20:21] offset:128
  global_load_dwordx4 v[64:67], v152, s[20:21] offset:192
  global_load_dwordx4 v[68:71], v153, s[20:21] offset:0
  global_load_dwordx4 v[72:75], v153, s[20:21] offset:64
  global_load_dwordx4 v[76:79], v153, s[20:21] offset:128
  global_load_dwordx4 v[80:83], v153, s[20:21] offset:192
  s_add_u32 s24, s16, 8192
  s_mov_b32 m0, s24
  s_nop 0
  global_load_lds_dwordx4 v154, s[22:23] offset:0 nt
  global_load_lds_dwordx4 v155, s[22:23] offset:1024 nt
  global_load_lds_dwordx4 v154, s[22:23] offset:2048 nt
  global_load_lds_dwordx4 v155, s[22:23] offset:3072 nt
  s_add_u32 s24, s16, 12288
  s_mov_b32 m0, s24
  s_nop 0
  global_load_lds_dwordx4 v156, s[22:23] offset:0 nt
  global_load_lds_dwordx4 v157, s[22:23] offset:1024 nt
  global_load_lds_dwordx4 v156, s[22:23] offset:2048 nt
  global_load_lds_dwordx4 v157, s[22:23] offset:3072 nt
  s_add_u32 s20, s20, 0x10000
  s_addc_u32 s21, s21, 0
  s_add_u32 s22, s22, 0x10000
  s_addc_u32 s23, s23, 0
  s_waitcnt vmcnt(16)
  v_mfma_f32_16x16x32_bf16 v[116:119], v[20:23], v[4:7], 0
  v_mfma_f32_16x16x32_bf16 v[116:119], v[24:27], v[8:11], v[116:119]
  v_mfma_f32_16x16x32_bf16 v[116:119], v[28:31], v[12:15], v[116:119]
  v_mfma_f32_16x16x32_bf16 v[116:119], v[32:35], v[16:19], v[116:119]
  v_mfma_f32_16x16x32_bf16 v[120:123], v[36:39], v[4:7], 0
  v_mfma_f32_16x16x32_bf16 v[120:123], v[40:43], v[8:11], v[120:123]
  v_mfma_f32_16x16x32_bf16 v[120:123], v[44:47], v[12:15], v[120:123]
  v_mfma_f32_16x16x32_bf16 v[120:123], v[48:51], v[16:19], v[120:123]
  ds_read_b64_tr_b16 v[128:129], v144 offset:0
  ds_read_b64_tr_b16 v[130:131], v144 offset:4096
  ds_read_b64_tr_b16 v[132:133], v145 offset:0
  ds_read_b64_tr_b16 v[134:135], v145 offset:4096
  ds_read_b64_tr_b16 v[136:137], v146 offset:0
  ds_read_b64_tr_b16 v[138:139], v146 offset:4096
  ds_read_b64_tr_b16 v[140:141], v147 offset:0
  ds_read_b64_tr_b16 v[142:143], v147 offset:4096
  s_nop 7
  v_cvt_pk_bf16_f32 v160, v116, v116
  v_lshlrev_b32 v116, 16, v160
  v_mul_f32 v116, 0x3db504f3, v116
  v_cvt_pk_bf16_f32 v160, v116, v116
  v_lshlrev_b32 v116, 16, v160
  v_cvt_pk_bf16_f32 v160, v117, v117
  v_lshlrev_b32 v117, 16, v160
  v_mul_f32 v117, 0x3db504f3, v117
  v_cvt_pk_bf16_f32 v160, v117, v117
  v_lshlrev_b32 v117, 16, v160
  v_cvt_pk_bf16_f32 v160, v118, v118
  v_lshlrev_b32 v118, 16, v160
  v_mul_f32 v118, 0x3db504f3, v118
  v_cvt_pk_bf16_f32 v160, v118, v118
  v_lshlrev_b32 v118, 16, v160
  v_cvt_pk_bf16_f32 v160, v119, v119
  v_lshlrev_b32 v119, 16, v160
  v_mul_f32 v119, 0x3db504f3, v119
  v_cvt_pk_bf16_f32 v160, v119, v119
  v_lshlrev_b32 v119, 16, v160
  v_cvt_pk_bf16_f32 v160, v120, v120
  v_lshlrev_b32 v120, 16, v160
  v_mul_f32 v120, 0x3db504f3, v120
  v_cvt_pk_bf16_f32 v160, v120, v120
  v_lshlrev_b32 v120, 16, v160
  v_cvt_pk_bf16_f32 v160, v121, v121
  v_lshlrev_b32 v121, 16, v160
  v_mul_f32 v121, 0x3db504f3, v121
  v_cvt_pk_bf16_f32 v160, v121, v121
  v_lshlrev_b32 v121, 16, v160
  v_cvt_pk_bf16_f32 v160, v122, v122
  v_lshlrev_b32 v122, 16, v160
  v_mul_f32 v122, 0x3db504f3, v122
  v_cvt_pk_bf16_f32 v160, v122, v122
  v_lshlrev_b32 v122, 16, v160
  v_cvt_pk_bf16_f32 v160, v123, v123
  v_lshlrev_b32 v123, 16, v160
  v_mul_f32 v123, 0x3db504f3, v123
  v_cvt_pk_bf16_f32 v160, v123, v123
  v_lshlrev_b32 v123, 16, v160
  v_max3_f32 v160, v116, v117, v118
  v_max3_f32 v160, v119, v120, v160
  v_max3_f32 v160, v121, v122, v160
  v_max_f32 v160, v123, v160
  v_mov_b32 v161, v160
  s_nop 1
  v_permlane16_swap_b32 v160, v161
  v_max_f32 v160, v160, v161
  v_mov_b32 v161, v160
  s_nop 1
  v_permlane32_swap_b32 v160, v161
  v_max_f32 v160, v160, v161
  v_max_f32 v160, v160, v158
  v_sub_f32 v161, v158, v160
  v_mul_f32 v161, 0x3fb8aa3b, v161
  v_exp_f32 v161, v161
  v_mov_b32 v158, v160
  v_sub_f32 v116, v116, v160
  v_mul_f32 v116, 0x3fb8aa3b, v116
  v_exp_f32 v116, v116
  v_sub_f32 v117, v117, v160
  v_mul_f32 v117, 0x3fb8aa3b, v117
  v_exp_f32 v117, v117
  v_sub_f32 v118, v118, v160
  v_mul_f32 v118, 0x3fb8aa3b, v118
  v_exp_f32 v118, v118
  v_sub_f32 v119, v119, v160
  v_mul_f32 v119, 0x3fb8aa3b, v119
  v_exp_f32 v119, v119
  v_sub_f32 v120, v120, v160
  v_mul_f32 v120, 0x3fb8aa3b, v120
  v_exp_f32 v120, v120
  v_sub_f32 v121, v121, v160
  v_mul_f32 v121, 0x3fb8aa3b, v121
  v_exp_f32 v121, v121
  v_sub_f32 v122, v122, v160
  v_mul_f32 v122, 0x3fb8aa3b, v122
  v_exp_f32 v122, v122
  v_sub_f32 v123, v123, v160
  v_mul_f32 v123, 0x3fb8aa3b, v123
  v_exp_f32 v123, v123
  v_mul_f32 v159, v159, v161
  v_cvt_pk_bf16_f32 v124, v116, v117
  v_cvt_pk_bf16_f32 v125, v118, v119
  v_cvt_pk_bf16_f32 v126, v120, v121
  v_cvt_pk_bf16_f32 v127, v122, v123
  v_add_f32 v159, v159, v116
  v_add_f32 v159, v159, v117
  v_add_f32 v159, v159, v118
  v_add_f32 v159, v159, v119
  v_add_f32 v159, v159, v120
  v_add_f32 v159, v159, v121
  v_add_f32 v159, v159, v122
  v_add_f32 v159, v159, v123
  v_readlane_b32 s30, v161, 0
  v_readlane_b32 s31, v161, 1
  v_readlane_b32 s32, v161, 2
  v_readlane_b32 s33, v161, 3
  s_nop 1
  v_mul_f32 v84, s30, v84
  v_mul_f32 v85, s31, v85
  v_mul_f32 v86, s32, v86
  v_mul_f32 v87, s33, v87
  v_mul_f32 v88, s30, v88
  v_mul_f32 v89, s31, v89
  v_mul_f32 v90, s32, v90
  v_mul_f32 v91, s33, v91
  v_mul_f32 v92, s30, v92
  v_mul_f32 v93, s31, v93
  v_mul_f32 v94, s32, v94
  v_mul_f32 v95, s33, v95
  v_mul_f32 v96, s30, v96
  v_mul_f32 v97, s31, v97
  v_mul_f32 v98, s32, v98
  v_mul_f32 v99, s33, v99
  v_mul_f32 v100, s30, v100
  v_mul_f32 v101, s31, v101
  v_mul_f32 v102, s32, v102
  v_mul_f32 v103, s33, v103
  v_mul_f32 v104, s30, v104
  v_mul_f32 v105, s31, v105
  v_mul_f32 v106, s32, v106
  v_mul_f32 v107, s33, v107
  v_mul_f32 v108, s30, v108
  v_mul_f32 v109, s31, v109
  v_mul_f32 v110, s32, v110
  v_mul_f32 v111, s33, v111
  v_mul_f32 v112, s30, v112
  v_mul_f32 v113, s31, v113
  v_mul_f32 v114, s32, v114
  v_mul_f32 v115, s33, v115
  s_waitcnt lgkmcnt(0)
  v_mfma_f32_16x16x32_bf16 v[84:87], v[124:127], v[128:131], v[84:87]
  v_mfma_f32_16x16x32_bf16 v[88:91], v[124:127], v[132:135], v[88:91]
  v_mfma_f32_16x16x32_bf16 v[92:95], v[124:127], v[136:139], v[92:95]
  v_mfma_f32_16x16x32_bf16 v[96:99], v[124:127], v[140:143], v[96:99]
  ds_read_b64_tr_b16 v[128:129], v148 offset:0
  ds_read_b64_tr_b16 v[130:131], v148 offset:4096
  ds_read_b64_tr_b16 v[132:133], v149 offset:0
  ds_read_b64_tr_b16 v[134:135], v149 offset:4096
  ds_read_b64_tr_b16 v[136:137], v150 offset:0
  ds_read_b64_tr_b16 v[138:139], v150 offset:4096
  ds_read_b64_tr_b16 v[140:141], v151 offset:0
  ds_read_b64_tr_b16 v[142:143], v151 offset:4096
  s_waitcnt lgkmcnt(0)
  v_mfma_f32_16x16x32_bf16 v[100:103], v[124:127], v[128:131], v[100:103]
  v_mfma_f32_16x16x32_bf16 v[104:107], v[124:127], v[132:135], v[104:107]
  v_mfma_f32_16x16x32_bf16 v[108:111], v[124:127], v[136:139], v[108:111]
  v_mfma_f32_16x16x32_bf16 v[112:115], v[124:127], v[140:143], v[112:115]
  s_nop 7
  s_waitcnt vmcnt(0)
  v_mfma_f32_16x16x32_bf16 v[116:119], v[52:55], v[4:7], 0
  v_mfma_f32_16x16x32_bf16 v[116:119], v[56:59], v[8:11], v[116:119]
  v_mfma_f32_16x16x32_bf16 v[116:119], v[60:63], v[12:15], v[116:119]
  v_mfma_f32_16x16x32_bf16 v[116:119], v[64:67], v[16:19], v[116:119]
  v_mfma_f32_16x16x32_bf16 v[120:123], v[68:71], v[4:7], 0
  v_mfma_f32_16x16x32_bf16 v[120:123], v[72:75], v[8:11], v[120:123]
  v_mfma_f32_16x16x32_bf16 v[120:123], v[76:79], v[12:15], v[120:123]
  v_mfma_f32_16x16x32_bf16 v[120:123], v[80:83], v[16:19], v[120:123]
  ds_read_b64_tr_b16 v[128:129], v144 offset:8192
  ds_read_b64_tr_b16 v[130:131], v144 offset:12288
  ds_read_b64_tr_b16 v[132:133], v145 offset:8192
  ds_read_b64_tr_b16 v[134:135], v145 offset:12288
  ds_read_b64_tr_b16 v[136:137], v146 offset:8192
  ds_read_b64_tr_b16 v[138:139], v146 offset:12288
  ds_read_b64_tr_b16 v[140:141], v147 offset:8192
  ds_read_b64_tr_b16 v[142:143], v147 offset:12288
  s_nop 7
  v_cvt_pk_bf16_f32 v160, v116, v116
  v_lshlrev_b32 v116, 16, v160
  v_mul_f32 v116, 0x3db504f3, v116
  v_cvt_pk_bf16_f32 v160, v116, v116
  v_lshlrev_b32 v116, 16, v160
  v_cvt_pk_bf16_f32 v160, v117, v117
  v_lshlrev_b32 v117, 16, v160
  v_mul_f32 v117, 0x3db504f3, v117
  v_cvt_pk_bf16_f32 v160, v117, v117
  v_lshlrev_b32 v117, 16, v160
  v_cvt_pk_bf16_f32 v160, v118, v118
  v_lshlrev_b32 v118, 16, v160
  v_mul_f32 v118, 0x3db504f3, v118
  v_cvt_pk_bf16_f32 v160, v118, v118
  v_lshlrev_b32 v118, 16, v160
  v_cvt_pk_bf16_f32 v160, v119, v119
  v_lshlrev_b32 v119, 16, v160
  v_mul_f32 v119, 0x3db504f3, v119
  v_cvt_pk_bf16_f32 v160, v119, v119
  v_lshlrev_b32 v119, 16, v160
  v_cvt_pk_bf16_f32 v160, v120, v120
  v_lshlrev_b32 v120, 16, v160
  v_mul_f32 v120, 0x3db504f3, v120
  v_cvt_pk_bf16_f32 v160, v120, v120
  v_lshlrev_b32 v120, 16, v160
  v_cvt_pk_bf16_f32 v160, v121, v121
  v_lshlrev_b32 v121, 16, v160
  v_mul_f32 v121, 0x3db504f3, v121
  v_cvt_pk_bf16_f32 v160, v121, v121
  v_lshlrev_b32 v121, 16, v160
  v_cvt_pk_bf16_f32 v160, v122, v122
  v_lshlrev_b32 v122, 16, v160
  v_mul_f32 v122, 0x3db504f3, v122
  v_cvt_pk_bf16_f32 v160, v122, v122
  v_lshlrev_b32 v122, 16, v160
  v_cvt_pk_bf16_f32 v160, v123, v123
  v_lshlrev_b32 v123, 16, v160
  v_mul_f32 v123, 0x3db504f3, v123
  v_cvt_pk_bf16_f32 v160, v123, v123
  v_lshlrev_b32 v123, 16, v160
  v_max3_f32 v160, v116, v117, v118
  v_max3_f32 v160, v119, v120, v160
  v_max3_f32 v160, v121, v122, v160
  v_max_f32 v160, v123, v160
  v_mov_b32 v161, v160
  s_nop 1
  v_permlane16_swap_b32 v160, v161
  v_max_f32 v160, v160, v161
  v_mov_b32 v161, v160
  s_nop 1
  v_permlane32_swap_b32 v160, v161
  v_max_f32 v160, v160, v161
  v_max_f32 v160, v160, v158
  v_sub_f32 v161, v158, v160
  v_mul_f32 v161, 0x3fb8aa3b, v161
  v_exp_f32 v161, v161
  v_mov_b32 v158, v160
  v_sub_f32 v116, v116, v160
  v_mul_f32 v116, 0x3fb8aa3b, v116
  v_exp_f32 v116, v116
  v_sub_f32 v117, v117, v160
  v_mul_f32 v117, 0x3fb8aa3b, v117
  v_exp_f32 v117, v117
  v_sub_f32 v118, v118, v160
  v_mul_f32 v118, 0x3fb8aa3b, v118
  v_exp_f32 v118, v118
  v_sub_f32 v119, v119, v160
  v_mul_f32 v119, 0x3fb8aa3b, v119
  v_exp_f32 v119, v119
  v_sub_f32 v120, v120, v160
  v_mul_f32 v120, 0x3fb8aa3b, v120
  v_exp_f32 v120, v120
  v_sub_f32 v121, v121, v160
  v_mul_f32 v121, 0x3fb8aa3b, v121
  v_exp_f32 v121, v121
  v_sub_f32 v122, v122, v160
  v_mul_f32 v122, 0x3fb8aa3b, v122
  v_exp_f32 v122, v122
  v_sub_f32 v123, v123, v160
  v_mul_f32 v123, 0x3fb8aa3b, v123
  v_exp_f32 v123, v123
  v_mul_f32 v159, v159, v161
  v_cvt_pk_bf16_f32 v124, v116, v117
  v_cvt_pk_bf16_f32 v125, v118, v119
  v_cvt_pk_bf16_f32 v126, v120, v121
  v_cvt_pk_bf16_f32 v127, v122, v123
  v_add_f32 v159, v159, v116
  v_add_f32 v159, v159, v117
  v_add_f32 v159, v159, v118
  v_add_f32 v159, v159, v119
  v_add_f32 v159, v159, v120
  v_add_f32 v159, v159, v121
  v_add_f32 v159, v159, v122
  v_add_f32 v159, v159, v123
  v_readlane_b32 s30, v161, 0
  v_readlane_b32 s31, v161, 1
  v_readlane_b32 s32, v161, 2
  v_readlane_b32 s33, v161, 3
  s_nop 1
  v_mul_f32 v84, s30, v84
  v_mul_f32 v85, s31, v85
  v_mul_f32 v86, s32, v86
  v_mul_f32 v87, s33, v87
  v_mul_f32 v88, s30, v88
  v_mul_f32 v89, s31, v89
  v_mul_f32 v90, s32, v90
  v_mul_f32 v91, s33, v91
  v_mul_f32 v92, s30, v92
  v_mul_f32 v93, s31, v93
  v_mul_f32 v94, s32, v94
  v_mul_f32 v95, s33, v95
  v_mul_f32 v96, s30, v96
  v_mul_f32 v97, s31, v97
  v_mul_f32 v98, s32, v98
  v_mul_f32 v99, s33, v99
  v_mul_f32 v100, s30, v100
  v_mul_f32 v101, s31, v101
  v_mul_f32 v102, s32, v102
  v_mul_f32 v103, s33, v103
  v_mul_f32 v104, s30, v104
  v_mul_f32 v105, s31, v105
  v_mul_f32 v106, s32, v106
  v_mul_f32 v107, s33, v107
  v_mul_f32 v108, s30, v108
  v_mul_f32 v109, s31, v109
  v_mul_f32 v110, s32, v110
  v_mul_f32 v111, s33, v111
  v_mul_f32 v112, s30, v112
  v_mul_f32 v113, s31, v113
  v_mul_f32 v114, s32, v114
  v_mul_f32 v115, s33, v115
  s_waitcnt lgkmcnt(0)
  v_mfma_f32_16x16x32_bf16 v[84:87], v[124:127], v[128:131], v[84:87]
  v_mfma_f32_16x16x32_bf16 v[88:91], v[124:127], v[132:135], v[88:91]
  v_mfma_f32_16x16x32_bf16 v[92:95], v[124:127], v[136:139], v[92:95]
  v_mfma_f32_16x16x32_bf16 v[96:99], v[124:127], v[140:143], v[96:99]
  ds_read_b64_tr_b16 v[128:129], v148 offset:8192
  ds_read_b64_tr_b16 v[130:131], v148 offset:12288
  ds_read_b64_tr_b16 v[132:133], v149 offset:8192
  ds_read_b64_tr_b16 v[134:135], v149 offset:12288
  ds_read_b64_tr_b16 v[136:137], v150 offset:8192
  ds_read_b64_tr_b16 v[138:139], v150 offset:12288
  ds_read_b64_tr_b16 v[140:141], v151 offset:8192
  ds_read_b64_tr_b16 v[142:143], v151 offset:12288
  s_waitcnt lgkmcnt(0)
  v_mfma_f32_16x16x32_bf16 v[100:103], v[124:127], v[128:131], v[100:103]
  v_mfma_f32_16x16x32_bf16 v[104:107], v[124:127], v[132:135], v[104:107]
  v_mfma_f32_16x16x32_bf16 v[108:111], v[124:127], v[136:139], v[108:111]
  v_mfma_f32_16x16x32_bf16 v[112:115], v[124:127], v[140:143], v[112:115]
  s_nop 7
  v_mov_b32 v160, v159
  s_nop 1
  v_permlane16_swap_b32 v159, v160
  v_add_f32 v159, v159, v160
  v_mov_b32 v160, v159
  s_nop 1
  v_permlane32_swap_b32 v159, v160
  v_add_f32 v159, v159, v160
  s_nop 7
  v_lshl_add_u32 v160, v1, 2, s16
  v_lshl_add_u32 v161, v1, 3, s16
  v_cmp_gt_u32 vcc, 16, v1
  s_and_saveexec_b64 s[26:27], vcc
  ds_write_b32 v160, v84 offset:0
  ds_write_b32 v160, v85 offset:512
  ds_write_b32 v160, v86 offset:1024
  ds_write_b32 v160, v87 offset:1536
  ds_write_b32 v160, v88 offset:64
  ds_write_b32 v160, v89 offset:576
  ds_write_b32 v160, v90 offset:1088
  ds_write_b32 v160, v91 offset:1600
  ds_write_b32 v160, v92 offset:128
  ds_write_b32 v160, v93 offset:640
  ds_write_b32 v160, v94 offset:1152
  ds_write_b32 v160, v95 offset:1664
  ds_write_b32 v160, v96 offset:192
  ds_write_b32 v160, v97 offset:704
  ds_write_b32 v160, v98 offset:1216
  ds_write_b32 v160, v99 offset:1728
  ds_write_b32 v160, v100 offset:256
  ds_write_b32 v160, v101 offset:768
  ds_write_b32 v160, v102 offset:1280
  ds_write_b32 v160, v103 offset:1792
  ds_write_b32 v160, v104 offset:320
  ds_write_b32 v160, v105 offset:832
  ds_write_b32 v160, v106 offset:1344
  ds_write_b32 v160, v107 offset:1856
  ds_write_b32 v160, v108 offset:384
  ds_write_b32 v160, v109 offset:896
  ds_write_b32 v160, v110 offset:1408
  ds_write_b32 v160, v111 offset:1920
  ds_write_b32 v160, v112 offset:448
  ds_write_b32 v160, v113 offset:960
  ds_write_b32 v160, v114 offset:1472
  ds_write_b32 v160, v115 offset:1984
  s_mov_b64 exec, s[26:27]
  v_cmp_gt_u32 vcc, 4, v1
  s_and_saveexec_b64 s[26:27], vcc
  ds_write_b64 v161, v[158:159] offset:2048
  s_mov_b64 exec, s[26:27]
  s_waitcnt lgkmcnt(0)
  s_barrier
  v_lshrrev_b32 v2, 7, v0
  v_lshlrev_b32 v3, 3, v2
  v_lshlrev_b32 v4, 2, v0
  v_add_u32 v12, 0x10000, v3
  v_add_u32 v13, 0x10000, v4
  ds_read_b64 v[20:21], v3 offset:2048
  ds_read_b64 v[22:23], v3 offset:18432
  ds_read_b64 v[24:25], v3 offset:34816
  ds_read_b64 v[26:27], v3 offset:51200
  ds_read_b64 v[28:29], v12 offset:2048
  ds_read_b64 v[30:31], v12 offset:18432
  ds_read_b64 v[32:33], v12 offset:34816
  ds_read_b64 v[34:35], v12 offset:51200
  ds_read_b32 v40, v4 offset:0
  ds_read_b32 v41, v4 offset:16384
  ds_read_b32 v42, v4 offset:32768
  ds_read_b32 v43, v4 offset:49152
  ds_read_b32 v44, v13 offset:0
  ds_read_b32 v45, v13 offset:16384
  ds_read_b32 v46, v13 offset:32768
  ds_read_b32 v47, v13 offset:49152
  s_waitcnt lgkmcnt(0)
  v_max3_f32 v5, v20, v22, v24
  v_max3_f32 v5, v26, v28, v5
  v_max3_f32 v5, v30, v32, v5
  v_max_f32 v5, v34, v5
  v_mov_b32 v6, 0
  v_mov_b32 v7, 0
  v_sub_f32 v8, v20, v5
  v_mul_f32 v8, 0x3fb8aa3b, v8
  v_exp_f32 v8, v8
  s_nop 0
  v_fmac_f32 v6, v8, v40
  v_fmac_f32 v7, v8, v21
  v_sub_f32 v8, v22, v5
  v_mul_f32 v8, 0x3fb8aa3b, v8
  v_exp_f32 v8, v8
  s_nop 0
  v_fmac_f32 v6, v8, v41
  v_fmac_f32 v7, v8, v23
  v_sub_f32 v8, v24, v5
  v_mul_f32 v8, 0x3fb8aa3b, v8
  v_exp_f32 v8, v8
  s_nop 0
  v_fmac_f32 v6, v8, v42
  v_fmac_f32 v7, v8, v25
  v_sub_f32 v8, v26, v5
  v_mul_f32 v8, 0x3fb8aa3b, v8
  v_exp_f32 v8, v8
  s_nop 0
  v_fmac_f32 v6, v8, v43
  v_fmac_f32 v7, v8, v27
  v_sub_f32 v8, v28, v5
  v_mul_f32 v8, 0x3fb8aa3b, v8
  v_exp_f32 v8, v8
  s_nop 0
  v_fmac_f32 v6, v8, v44
  v_fmac_f32 v7, v8, v29
  v_sub_f32 v8, v30, v5
  v_mul_f32 v8, 0x3fb8aa3b, v8
  v_exp_f32 v8, v8
  s_nop 0
  v_fmac_f32 v6, v8, v45
  v_fmac_f32 v7, v8, v31
  v_sub_f32 v8, v32, v5
  v_mul_f32 v8, 0x3fb8aa3b, v8
  v_exp_f32 v8, v8
  s_nop 0
  v_fmac_f32 v6, v8, v46
  v_fmac_f32 v7, v8, v33
  v_sub_f32 v8, v34, v5
  v_mul_f32 v8, 0x3fb8aa3b, v8
  v_exp_f32 v8, v8
  s_nop 0
  v_fmac_f32 v6, v8, v47
  v_fmac_f32 v7, v8, v35
  s_lshl_b32 s24, s13, 2
  v_add_u32 v9, s24, v2
  v_lshlrev_b32 v9, 5, v9
  v_add_u32 v9, s14, v9
  v_and_b32 v10, 127, v0
  v_lshlrev_b32 v11, 9, v9
  v_lshl_add_u32 v11, v10, 2, v11
  v_add_u32 v11, 65536, v11
  global_store_dword v11, v6, s[8:9]
  v_cmp_eq_u32 vcc, 0, v10
  s_and_saveexec_b64 s[26:27], vcc
  v_lshlrev_b32 v11, 3, v9
  v_add_u32 v11, 16384, v11
  v_mov_b32 v6, v5
  global_store_dwordx2 v11, v[6:7], s[8:9]
L_a_end:
  s_endpgm
.section .rodata,"a"
.p2align 6
.amdhsa_kernel attn_kernel
  .amdhsa_next_free_vgpr 176
  .amdhsa_next_free_sgpr 96
  .amdhsa_accum_offset 176
  .amdhsa_group_segment_fixed_size 0
  .amdhsa_kernarg_size 104
  .amdhsa_user_sgpr_count 2
  .amdhsa_user_sgpr_kernarg_segment_ptr 1
  .amdhsa_system_sgpr_workgroup_id_x 1
.end_amdhsa_kernel
.text
.globl oproj_kernel
.p2align 8
.type oproj_kernel,@function
oproj_kernel:
  s_cmp_ge_u32 s2, 256
  s_cbranch_scc1 L_o_end
  s_load_dwordx2 s[6:7], s[0:1], 32
  s_load_dwordx2 s[8:9], s[0:1], 96
  s_lshr_b32 s12, s2, 3
  s_and_b32 s13, s2, 7
  v_and_b32 v1, 63, v0
  v_lshrrev_b32 v2, 6, v0
  s_nop 0
  v_readfirstlane_b32 s14, v2
  v_and_b32 v3, 7, v0
  v_lshrrev_b32 v4, 3, v0
  s_lshl_b32 s15, s12, 17
  s_lshl_b32 s16, s13, 7
  s_add_u32 s15, s15, s16
  v_lshlrev_b32 v5, 10, v4
  v_lshl_add_u32 v5, v3, 4, v5
  v_add_u32 v5, s15, v5
  v_and_b32 v6, 31, v1
  v_lshlrev_b32 v6, 3, v6
  s_lshl_b32 s17, s12, 8
  s_add_u32 s17, s17, 16384
  v_add_u32 v6, s17, v6
  v_and_b32 v7, 127, v0
  v_lshrrev_b32 v8, 7, v0
  v_lshlrev_b32 v9, 13, v8
  v_lshl_add_u32 v9, v7, 2, v9
  s_lshl_b32 s18, s12, 14
  s_add_u32 s18, s18, 65536
  v_add_u32 v9, s18, v9
  s_waitcnt lgkmcnt(0)
  global_load_dwordx2 v[10:11], v6, s[8:9]
  global_load_dword v48, v9, s[8:9] offset:0
  global_load_dword v49, v9, s[8:9] offset:512
  global_load_dword v50, v9, s[8:9] offset:1024
  global_load_dword v51, v9, s[8:9] offset:1536
  global_load_dword v52, v9, s[8:9] offset:2048
  global_load_dword v53, v9, s[8:9] offset:2560
  global_load_dword v54, v9, s[8:9] offset:3072
  global_load_dword v55, v9, s[8:9] offset:3584
  v_add_u32 v9, 4096, v9
  global_load_dword v56, v9, s[8:9] offset:0
  global_load_dword v57, v9, s[8:9] offset:512
  global_load_dword v58, v9, s[8:9] offset:1024
  global_load_dword v59, v9, s[8:9] offset:1536
  global_load_dword v60, v9, s[8:9] offset:2048
  global_load_dword v61, v9, s[8:9] offset:2560
  global_load_dword v62, v9, s[8:9] offset:3072
  global_load_dword v63, v9, s[8:9] offset:3584
  global_load_dwordx4 v[32:35], v5, s[6:7]
  v_add_u32 v5, 0x8000, v5
  global_load_dwordx4 v[36:39], v5, s[6:7]
  v_add_u32 v5, 0x8000, v5
  global_load_dwordx4 v[40:43], v5, s[6:7]
  v_add_u32 v5, 0x8000, v5
  global_load_dwordx4 v[44:47], v5, s[6:7]
  s_waitcnt vmcnt(20)
  v_mov_b32 v12, v10
  s_nop 1
  v_mov_b32_dpp v13, v12 quad_perm:[1,0,3,2] row_mask:0xf bank_mask:0xf
  v_max_f32 v12, v12, v13
  s_nop 1
  v_mov_b32_dpp v13, v12 quad_perm:[2,3,0,1] row_mask:0xf bank_mask:0xf
  v_max_f32 v12, v12, v13
  s_nop 1
  v_mov_b32_dpp v13, v12 row_half_mirror row_mask:0xf bank_mask:0xf
  v_max_f32 v12, v12, v13
  s_nop 1
  v_mov_b32_dpp v13, v12 row_mirror row_mask:0xf bank_mask:0xf
  v_max_f32 v12, v12, v13
  v_mov_b32 v13, v12
  s_nop 1
  v_permlane16_swap_b32 v12, v13
  v_max_f32 v12, v12, v13
  v_mov_b32 v13, v12
  s_nop 1
  v_permlane32_swap_b32 v12, v13
  v_max_f32 v12, v12, v13
  v_sub_f32 v12, v10, v12
  v_mul_f32 v12, 0x3fb8aa3b, v12
  v_exp_f32 v12, v12
  s_nop 0
  v_mul_f32 v13, v12, v11
  v_cmp_gt_u32 vcc, 32, v1
  s_nop 1
  v_cndmask_b32 v13, 0, v13, vcc
  s_nop 1
  v_mov_b32_dpp v14, v13 quad_perm:[1,0,3,2] row_mask:0xf bank_mask:0xf
  v_add_f32 v13, v13, v14
  s_nop 1
  v_mov_b32_dpp v14, v13 quad_perm:[2,3,0,1] row_mask:0xf bank_mask:0xf
  v_add_f32 v13, v13, v14
  s_nop 1
  v_mov_b32_dpp v14, v13 row_half_mirror row_mask:0xf bank_mask:0xf
  v_add_f32 v13, v13, v14
  s_nop 1
  v_mov_b32_dpp v14, v13 row_mirror row_mask:0xf bank_mask:0xf
  v_add_f32 v13, v13, v14
  v_mov_b32 v14, v13
  s_nop 1
  v_permlane16_swap_b32 v13, v14
  v_add_f32 v13, v13, v14
  v_mov_b32 v14, v13
  s_nop 1
  v_permlane32_swap_b32 v13, v14
  v_add_f32 v13, v13, v14
  v_rcp_f32 v13, v13
  s_nop 0
  v_mul_f32 v12, v12, v13
  s_lshr_b32 s19, s14, 1
  s_lshl_b32 s19, s19, 4
  v_mov_b32 v14, 0
  s_waitcnt vmcnt(4)
  s_add_u32 s20, s19, 0
  s_nop 3
  v_readlane_b32 s21, v12, s20
  s_nop 1
  v_fmac_f32 v14, s21, v48
  s_add_u32 s20, s19, 1
  s_nop 3
  v_readlane_b32 s21, v12, s20
  s_nop 1
  v_fmac_f32 v14, s21, v49
  s_add_u32 s20, s19, 2
  s_nop 3
  v_readlane_b32 s21, v12, s20
  s_nop 1
  v_fmac_f32 v14, s21, v50
  s_add_u32 s20, s19, 3
  s_nop 3
  v_readlane_b32 s21, v12, s20
  s_nop 1
  v_fmac_f32 v14, s21, v51
  s_add_u32 s20, s19, 4
  s_nop 3
  v_readlane_b32 s21, v12, s20
  s_nop 1
  v_fmac_f32 v14, s21, v52
  s_add_u32 s20, s19, 5
  s_nop 3
  v_readlane_b32 s21, v12, s20
  s_nop 1
  v_fmac_f32 v14, s21, v53
  s_add_u32 s20, s19, 6
  s_nop 3
  v_readlane_b32 s21, v12, s20
  s_nop 1
  v_fmac_f32 v14, s21, v54
  s_add_u32 s20, s19, 7
  s_nop 3
  v_readlane_b32 s21, v12, s20
  s_nop 1
  v_fmac_f32 v14, s21, v55
  s_add_u32 s20, s19, 8
  s_nop 3
  v_readlane_b32 s21, v12, s20
  s_nop 1
  v_fmac_f32 v14, s21, v56
  s_add_u32 s20, s19, 9
  s_nop 3
  v_readlane_b32 s21, v12, s20
  s_nop 1
  v_fmac_f32 v14, s21, v57
  s_add_u32 s20, s19, 10
  s_nop 3
  v_readlane_b32 s21, v12, s20
  s_nop 1
  v_fmac_f32 v14, s21, v58
  s_add_u32 s20, s19, 11
  s_nop 3
  v_readlane_b32 s21, v12, s20
  s_nop 1
  v_fmac_f32 v14, s21, v59
  s_add_u32 s20, s19, 12
  s_nop 3
  v_readlane_b32 s21, v12, s20
  s_nop 1
  v_fmac_f32 v14, s21, v60
  s_add_u32 s20, s19, 13
  s_nop 3
  v_readlane_b32 s21, v12, s20
  s_nop 1
  v_fmac_f32 v14, s21, v61
  s_add_u32 s20, s19, 14
  s_nop 3
  v_readlane_b32 s21, v12, s20
  s_nop 1
  v_fmac_f32 v14, s21, v62
  s_add_u32 s20, s19, 15
  s_nop 3
  v_readlane_b32 s21, v12, s20
  s_nop 1
  v_fmac_f32 v14, s21, v63
  v_lshlrev_b32 v15, 2, v0
  ds_write_b32 v15, v14
  s_waitcnt lgkmcnt(0)
  s_barrier
  v_lshlrev_b32 v15, 2, v4
  ds_read_b32 v16, v15 offset:0
  ds_read_b32 v20, v15 offset:512
  ds_read_b32 v17, v15 offset:128
  ds_read_b32 v21, v15 offset:640
  ds_read_b32 v18, v15 offset:256
  ds_read_b32 v22, v15 offset:768
  ds_read_b32 v19, v15 offset:384
  ds_read_b32 v23, v15 offset:896
  v_mov_b32 v64, 0
  v_mov_b32 v65, 0
  v_mov_b32 v66, 0
  v_mov_b32 v67, 0
  v_mov_b32 v68, 0
  v_mov_b32 v69, 0
  v_mov_b32 v70, 0
  v_mov_b32 v71, 0
  s_waitcnt lgkmcnt(0)
  v_add_f32 v16, v16, v20
  v_cvt_pk_bf16_f32 v24, v16, v16
  v_lshlrev_b32 v16, 16, v24
  v_add_f32 v17, v17, v21
  v_cvt_pk_bf16_f32 v24, v17, v17
  v_lshlrev_b32 v17, 16, v24
  v_add_f32 v18, v18, v22
  v_cvt_pk_bf16_f32 v24, v18, v18
  v_lshlrev_b32 v18, 16, v24
  v_add_f32 v19, v19, v23
  v_cvt_pk_bf16_f32 v24, v19, v19
  v_lshlrev_b32 v19, 16, v24
  s_waitcnt vmcnt(0)
  v_lshlrev_b32 v24, 16, v32
  v_fmac_f32 v64, v16, v24
  v_and_b32 v24, 0xffff0000, v32
  v_fmac_f32 v65, v16, v24
  v_lshlrev_b32 v24, 16, v33
  v_fmac_f32 v66, v16, v24
  v_and_b32 v24, 0xffff0000, v33
  v_fmac_f32 v67, v16, v24
  v_lshlrev_b32 v24, 16, v34
  v_fmac_f32 v68, v16, v24
  v_and_b32 v24, 0xffff0000, v34
  v_fmac_f32 v69, v16, v24
  v_lshlrev_b32 v24, 16, v35
  v_fmac_f32 v70, v16, v24
  v_and_b32 v24, 0xffff0000, v35
  v_fmac_f32 v71, v16, v24
  v_lshlrev_b32 v24, 16, v36
  v_fmac_f32 v64, v17, v24
  v_and_b32 v24, 0xffff0000, v36
  v_fmac_f32 v65, v17, v24
  v_lshlrev_b32 v24, 16, v37
  v_fmac_f32 v66, v17, v24
  v_and_b32 v24, 0xffff0000, v37
  v_fmac_f32 v67, v17, v24
  v_lshlrev_b32 v24, 16, v38
  v_fmac_f32 v68, v17, v24
  v_and_b32 v24, 0xffff0000, v38
  v_fmac_f32 v69, v17, v24
  v_lshlrev_b32 v24, 16, v39
  v_fmac_f32 v70, v17, v24
  v_and_b32 v24, 0xffff0000, v39
  v_fmac_f32 v71, v17, v24
  v_lshlrev_b32 v24, 16, v40
  v_fmac_f32 v64, v18, v24
  v_and_b32 v24, 0xffff0000, v40
  v_fmac_f32 v65, v18, v24
  v_lshlrev_b32 v24, 16, v41
  v_fmac_f32 v66, v18, v24
  v_and_b32 v24, 0xffff0000, v41
  v_fmac_f32 v67, v18, v24
  v_lshlrev_b32 v24, 16, v42
  v_fmac_f32 v68, v18, v24
  v_and_b32 v24, 0xffff0000, v42
  v_fmac_f32 v69, v18, v24
  v_lshlrev_b32 v24, 16, v43
  v_fmac_f32 v70, v18, v24
  v_and_b32 v24, 0xffff0000, v43
  v_fmac_f32 v71, v18, v24
  v_lshlrev_b32 v24, 16, v44
  v_fmac_f32 v64, v19, v24
  v_and_b32 v24, 0xffff0000, v44
  v_fmac_f32 v65, v19, v24
  v_lshlrev_b32 v24, 16, v45
  v_fmac_f32 v66, v19, v24
  v_and_b32 v24, 0xffff0000, v45
  v_fmac_f32 v67, v19, v24
  v_lshlrev_b32 v24, 16, v46
  v_fmac_f32 v68, v19, v24
  v_and_b32 v24, 0xffff0000, v46
  v_fmac_f32 v69, v19, v24
  v_lshlrev_b32 v24, 16, v47
  v_fmac_f32 v70, v19, v24
  v_and_b32 v24, 0xffff0000, v47
  v_fmac_f32 v71, v19, v24
  s_nop 1
  v_mov_b32_dpp v24, v64 row_ror:8 row_mask:0xf bank_mask:0xf
  v_add_f32 v64, v64, v24
  v_mov_b32 v24, v64
  s_nop 1
  v_permlane16_swap_b32 v64, v24
  v_add_f32 v64, v64, v24
  v_mov_b32 v24, v64
  s_nop 1
  v_permlane32_swap_b32 v64, v24
  v_add_f32 v64, v64, v24
  s_nop 1
  v_mov_b32_dpp v24, v65 row_ror:8 row_mask:0xf bank_mask:0xf
  v_add_f32 v65, v65, v24
  v_mov_b32 v24, v65
  s_nop 1
  v_permlane16_swap_b32 v65, v24
  v_add_f32 v65, v65, v24
  v_mov_b32 v24, v65
  s_nop 1
  v_permlane32_swap_b32 v65, v24
  v_add_f32 v65, v65, v24
  s_nop 1
  v_mov_b32_dpp v24, v66 row_ror:8 row_mask:0xf bank_mask:0xf
  v_add_f32 v66, v66, v24
  v_mov_b32 v24, v66
  s_nop 1
  v_permlane16_swap_b32 v66, v24
  v_add_f32 v66, v66, v24
  v_mov_b32 v24, v66
  s_nop 1
  v_permlane32_swap_b32 v66, v24
  v_add_f32 v66, v66, v24
  s_nop 1
  v_mov_b32_dpp v24, v67 row_ror:8 row_mask:0xf bank_mask:0xf
  v_add_f32 v67, v67, v24
  v_mov_b32 v24, v67
  s_nop 1
  v_permlane16_swap_b32 v67, v24
  v_add_f32 v67, v67, v24
  v_mov_b32 v24, v67
  s_nop 1
  v_permlane32_swap_b32 v67, v24
  v_add_f32 v67, v67, v24
  s_nop 1
  v_mov_b32_dpp v24, v68 row_ror:8 row_mask:0xf bank_mask:0xf
  v_add_f32 v68, v68, v24
  v_mov_b32 v24, v68
  s_nop 1
  v_permlane16_swap_b32 v68, v24
  v_add_f32 v68, v68, v24
  v_mov_b32 v24, v68
  s_nop 1
  v_permlane32_swap_b32 v68, v24
  v_add_f32 v68, v68, v24
  s_nop 1
  v_mov_b32_dpp v24, v69 row_ror:8 row_mask:0xf bank_mask:0xf
  v_add_f32 v69, v69, v24
  v_mov_b32 v24, v69
  s_nop 1
  v_permlane16_swap_b32 v69, v24
  v_add_f32 v69, v69, v24
  v_mov_b32 v24, v69
  s_nop 1
  v_permlane32_swap_b32 v69, v24
  v_add_f32 v69, v69, v24
  s_nop 1
  v_mov_b32_dpp v24, v70 row_ror:8 row_mask:0xf bank_mask:0xf
  v_add_f32 v70, v70, v24
  v_mov_b32 v24, v70
  s_nop 1
  v_permlane16_swap_b32 v70, v24
  v_add_f32 v70, v70, v24
  v_mov_b32 v24, v70
  s_nop 1
  v_permlane32_swap_b32 v70, v24
  v_add_f32 v70, v70, v24
  s_nop 1
  v_mov_b32_dpp v24, v71 row_ror:8 row_mask:0xf bank_mask:0xf
  v_add_f32 v71, v71, v24
  v_mov_b32 v24, v71
  s_nop 1
  v_permlane16_swap_b32 v71, v24
  v_add_f32 v71, v71, v24
  v_mov_b32 v24, v71
  s_nop 1
  v_permlane32_swap_b32 v71, v24
  v_add_f32 v71, v71, v24
  v_lshlrev_b32 v7, 8, v2
  v_lshl_add_u32 v7, v1, 5, v7
  v_add_u32 v7, 1024, v7
  v_cmp_gt_u32 vcc, 8, v1
  s_and_saveexec_b64 s[10:11], vcc
  ds_write_b128 v7, v[64:67]
  ds_write_b128 v7, v[68:71] offset:16
  s_mov_b64 exec, s[10:11]
  s_waitcnt lgkmcnt(0)
  s_barrier
  v_cmp_gt_u32 vcc, 64, v0
  s_and_saveexec_b64 s[10:11], vcc
  s_cbranch_execz L_o_end
  v_lshlrev_b32 v7, 2, v0
  ds_read_b32 v8, v7 offset:1024
  ds_read_b32 v9, v7 offset:1280
  ds_read_b32 v10, v7 offset:1536
  ds_read_b32 v11, v7 offset:1792
  s_waitcnt lgkmcnt(0)
  v_add_f32 v8, v8, v9
  v_add_f32 v10, v10, v11
  v_add_f32 v8, v8, v10
  s_lshl_b32 s16, s13, 8
  s_add_u32 s16, s16, 8192
  v_add_u32 v7, s16, v7
  global_atomic_add_f32 v7, v8, s[8:9]
L_o_end:
  s_endpgm
.section .rodata,"a"
.p2align 6
.amdhsa_kernel oproj_kernel
  .amdhsa_next_free_vgpr 80
  .amdhsa_next_free_sgpr 96
  .amdhsa_accum_offset 80
  .amdhsa_group_segment_fixed_size 0
  .amdhsa_kernarg_size 104
  .amdhsa_user_sgpr_count 2
  .amdhsa_user_sgpr_kernarg_segment_ptr 1
  .amdhsa_system_sgpr_workgroup_id_x 1
.end_amdhsa_kernel
.text
.globl mlp_kernel
.p2align 8
.type mlp_kernel,@function
mlp_kernel:
  s_cmp_ge_u32 s2, 56
  s_cbranch_scc1 L_m_end
  s_load_dwordx2 s[4:5], s[0:1], 0
  s_load_dwordx2 s[6:7], s[0:1], 48
  s_load_dwordx2 s[10:11], s[0:1], 56
  s_load_dwordx2 s[12:13], s[0:1], 64
  s_load_dwordx2 s[14:15], s[0:1], 72
  s_load_dwordx2 s[16:17], s[0:1], 80
  s_load_dwordx2 s[18:19], s[0:1], 88
  s_load_dwordx2 s[8:9], s[0:1], 96
  v_and_b32 v1, 63, v0
  v_and_b32 v2, 15, v1
  v_lshrrev_b32 v3, 4, v1
  v_lshrrev_b32 v4, 6, v0
  s_nop 0
  v_readfirstlane_b32 s20, v4
  v_lshrrev_b32 v5, 2, v1
  v_mul_u32_u24 v5, 3584, v5
  v_and_b32 v4, 3, v1
  v_lshl_add_u32 v5, v4, 4, v5
  s_lshl_b32 s21, s2, 6
  v_add_u32 v5, s21, v5
  v_lshlrev_b32 v6, 4, v1
  s_mul_i32 s22, s20, 458752
  s_lshl_b32 s23, s2, 15
  s_lshl_b32 s24, s20, 13
  s_add_u32 s23, s23, s24
  s_waitcnt lgkmcnt(0)
  s_add_u32 s6, s6, s22
  s_addc_u32 s7, s7, 0
  s_add_u32 s12, s12, s23
  s_addc_u32 s13, s13, 0
  s_cmp_lg_u32 s20, 0
  s_cbranch_scc1 L_m_dma
  v_and_b32 v9, 31, v1
  v_lshlrev_b32 v9, 1, v9
  v_add_u32 v9, s21, v9
  v_lshlrev_b32 v8, 5, v1
  v_add_u32 v8, 8192, v8
  global_load_dwordx4 v[12:15], v6, s[4:5]
  global_load_dwordx4 v[16:19], v8, s[8:9]
  global_load_dwordx4 v[20:23], v8, s[8:9] offset:16
  global_load_ushort v10, v9, s[10:11]
  global_load_dwordx4 v[40:43], v6, s[14:15]
L_m_dma:
  s_lshl_b32 s25, s20, 13
  s_add_u32 s26, s25, 2048
  s_mov_b32 m0, s26
  s_nop 0
  global_load_lds_dwordx4 v5, s[6:7]
  s_add_u32 s6, s6, 57344
  s_addc_u32 s7, s7, 0
  s_add_u32 s26, s25, 3072
  s_mov_b32 m0, s26
  s_nop 0
  global_load_lds_dwordx4 v5, s[6:7]
  s_add_u32 s6, s6, 57344
  s_addc_u32 s7, s7, 0
  s_add_u32 s26, s25, 4096
  s_mov_b32 m0, s26
  s_nop 0
  global_load_lds_dwordx4 v5, s[6:7]
  s_add_u32 s6, s6, 57344
  s_addc_u32 s7, s7, 0
  s_add_u32 s26, s25, 5120
  s_mov_b32 m0, s26
  s_nop 0
  global_load_lds_dwordx4 v5, s[6:7]
  s_add_u32 s6, s6, 57344
  s_addc_u32 s7, s7, 0
  s_add_u32 s26, s25, 6144
  s_mov_b32 m0, s26
  s_nop 0
  global_load_lds_dwordx4 v5, s[6:7]
  s_add_u32 s6, s6, 57344
  s_addc_u32 s7, s7, 0
  s_add_u32 s26, s25, 7168
  s_mov_b32 m0, s26
  s_nop 0
  global_load_lds_dwordx4 v5, s[6:7]
  s_add_u32 s6, s6, 57344
  s_addc_u32 s7, s7, 0
  s_add_u32 s26, s25, 8192
  s_mov_b32 m0, s26
  s_nop 0
  global_load_lds_dwordx4 v5, s[6:7]
  s_add_u32 s6, s6, 57344
  s_addc_u32 s7, s7, 0
  s_add_u32 s26, s25, 9216
  s_mov_b32 m0, s26
  s_nop 0
  global_load_lds_dwordx4 v5, s[6:7]
  s_add_u32 s6, s6, 57344
  s_addc_u32 s7, s7, 0
  s_mul_i32 s25, s20, 8448
  s_add_u32 s26, s25, 34816
  s_mov_b32 m0, s26
  s_nop 0
  global_load_lds_dwordx4 v6, s[12:13]
  s_add_u32 s12, s12, 1024
  s_addc_u32 s13, s13, 0
  s_add_u32 s26, s25, 35872
  s_mov_b32 m0, s26
  s_nop 0
  global_load_lds_dwordx4 v6, s[12:13]
  s_add_u32 s12, s12, 1024
  s_addc_u32 s13, s13, 0
  s_add_u32 s26, s25, 36928
  s_mov_b32 m0, s26
  s_nop 0
  global_load_lds_dwordx4 v6, s[12:13]
  s_add_u32 s12, s12, 1024
  s_addc_u32 s13, s13, 0
  s_add_u32 s26, s25, 37984
  s_mov_b32 m0, s26
  s_nop 0
  global_load_lds_dwordx4 v6, s[12:13]
  s_add_u32 s12, s12, 1024
  s_addc_u32 s13, s13, 0
  s_add_u32 s26, s25, 39040
  s_mov_b32 m0, s26
  s_nop 0
  global_load_lds_dwordx4 v6, s[12:13]
  s_add_u32 s12, s12, 1024
  s_addc_u32 s13, s13, 0
  s_add_u32 s26, s25, 40096
  s_mov_b32 m0, s26
  s_nop 0
  global_load_lds_dwordx4 v6, s[12:13]
  s_add_u32 s12, s12, 1024
  s_addc_u32 s13, s13, 0
  s_add_u32 s26, s25, 41152
  s_mov_b32 m0, s26
  s_nop 0
  global_load_lds_dwordx4 v6, s[12:13]
  s_add_u32 s12, s12, 1024
  s_addc_u32 s13, s13, 0
  s_add_u32 s26, s25, 42208
  s_mov_b32 m0, s26
  s_nop 0
  global_load_lds_dwordx4 v6, s[12:13]
  s_add_u32 s12, s12, 1024
  s_addc_u32 s13, s13, 0
  s_cmp_eq_u32 s20, 0
  s_cbranch_scc1 L_m_w0
  s_waitcnt vmcnt(0)
  s_barrier
  s_endpgm
L_m_w0:
  v_lshrrev_b32 v208, 2, v2
  v_lshl_add_u32 v208, v3, 3, v208
  v_mul_u32_u24 v208, 64, v208
  v_and_b32 v209, 3, v2
  v_lshl_add_u32 v208, v209, 3, v208
  v_lshrrev_b32 v210, 2, v2
  v_lshl_add_u32 v210, v3, 3, v210
  v_mul_u32_u24 v210, 1056, v210
  v_and_b32 v211, 3, v2
  v_lshl_add_u32 v210, v211, 3, v210
  v_add_u32 v210, 34816, v210
  s_waitcnt vmcnt(16)
  v_lshlrev_b32 v24, 16, v12
  v_and_b32 v25, 0xffff0000, v12
  v_lshlrev_b32 v26, 16, v13
  v_and_b32 v27, 0xffff0000, v13
  v_lshlrev_b32 v28, 16, v14
  v_and_b32 v29, 0xffff0000, v14
  v_lshlrev_b32 v30, 16, v15
  v_and_b32 v31, 0xffff0000, v15
  v_cvt_pk_bf16_f32 v36, v16, v16
  v_lshlrev_b32 v16, 16, v36
  v_add_f32 v16, v16, v24
  v_cvt_pk_bf16_f32 v36, v16, v16
  v_lshlrev_b32 v16, 16, v36
  v_mov_b32 v24, v16
  v_cvt_pk_bf16_f32 v36, v17, v17
  v_lshlrev_b32 v17, 16, v36
  v_add_f32 v17, v17, v25
  v_cvt_pk_bf16_f32 v36, v17, v17
  v_lshlrev_b32 v17, 16, v36
  v_mov_b32 v25, v17
  v_cvt_pk_bf16_f32 v36, v18, v18
  v_lshlrev_b32 v18, 16, v36
  v_add_f32 v18, v18, v26
  v_cvt_pk_bf16_f32 v36, v18, v18
  v_lshlrev_b32 v18, 16, v36
  v_mov_b32 v26, v18
  v_cvt_pk_bf16_f32 v36, v19, v19
  v_lshlrev_b32 v19, 16, v36
  v_add_f32 v19, v19, v27
  v_cvt_pk_bf16_f32 v36, v19, v19
  v_lshlrev_b32 v19, 16, v36
  v_mov_b32 v27, v19
  v_cvt_pk_bf16_f32 v36, v20, v20
  v_lshlrev_b32 v20, 16, v36
  v_add_f32 v20, v20, v28
  v_cvt_pk_bf16_f32 v36, v20, v20
  v_lshlrev_b32 v20, 16, v36
  v_mov_b32 v28, v20
  v_cvt_pk_bf16_f32 v36, v21, v21
  v_lshlrev_b32 v21, 16, v36
  v_add_f32 v21, v21, v29
  v_cvt_pk_bf16_f32 v36, v21, v21
  v_lshlrev_b32 v21, 16, v36
  v_mov_b32 v29, v21
  v_cvt_pk_bf16_f32 v36, v22, v22
  v_lshlrev_b32 v22, 16, v36
  v_add_f32 v22, v22, v30
  v_cvt_pk_bf16_f32 v36, v22, v22
  v_lshlrev_b32 v22, 16, v36
  v_mov_b32 v30, v22
  v_cvt_pk_bf16_f32 v36, v23, v23
  v_lshlrev_b32 v23, 16, v36
  v_add_f32 v23, v23, v31
  v_cvt_pk_bf16_f32 v36, v23, v23
  v_lshlrev_b32 v23, 16, v36
  v_mov_b32 v31, v23
  v_add_f32 v36, v16, v17
  v_add_f32 v36, v36, v18
  v_add_f32 v36, v36, v19
  v_add_f32 v36, v36, v20
  v_add_f32 v36, v36, v21
  v_add_f32 v36, v36, v22
  v_add_f32 v36, v36, v23
  s_nop 1
  v_mov_b32_dpp v37, v36 quad_perm:[1,0,3,2] row_mask:0xf bank_mask:0xf
  v_add_f32 v36, v36, v37
  s_nop 1
  v_mov_b32_dpp v37, v36 quad_perm:[2,3,0,1] row_mask:0xf bank_mask:0xf
  v_add_f32 v36, v36, v37
  s_nop 1
  v_mov_b32_dpp v37, v36 row_half_mirror row_mask:0xf bank_mask:0xf
  v_add_f32 v36, v36, v37
  s_nop 1
  v_mov_b32_dpp v37, v36 row_mirror row_mask:0xf bank_mask:0xf
  v_add_f32 v36, v36, v37
  v_mov_b32 v37, v36
  s_nop 1
  v_permlane16_swap_b32 v36, v37
  v_add_f32 v36, v36, v37
  v_mov_b32 v37, v36
  s_nop 1
  v_permlane32_swap_b32 v36, v37
  v_add_f32 v36, v36, v37
  v_mul_f32 v36, 0x3b000000, v36
  v_sub_f32 v37, v16, v36
  v_mul_f32 v38, v37, v37
  v_sub_f32 v37, v17, v36
  v_fmac_f32 v38, v37, v37
  v_sub_f32 v37, v18, v36
  v_fmac_f32 v38, v37, v37
  v_sub_f32 v37, v19, v36
  v_fmac_f32 v38, v37, v37
  v_sub_f32 v37, v20, v36
  v_fmac_f32 v38, v37, v37
  v_sub_f32 v37, v21, v36
  v_fmac_f32 v38, v37, v37
  v_sub_f32 v37, v22, v36
  v_fmac_f32 v38, v37, v37
  v_sub_f32 v37, v23, v36
  v_fmac_f32 v38, v37, v37
  s_nop 1
  v_mov_b32_dpp v37, v38 quad_perm:[1,0,3,2] row_mask:0xf bank_mask:0xf
  v_add_f32 v38, v38, v37
  s_nop 1
  v_mov_b32_dpp v37, v38 quad_perm:[2,3,0,1] row_mask:0xf bank_mask:0xf
  v_add_f32 v38, v38, v37
  s_nop 1
  v_mov_b32_dpp v37, v38 row_half_mirror row_mask:0xf bank_mask:0xf
  v_add_f32 v38, v38, v37
  s_nop 1
  v_mov_b32_dpp v37, v38 row_mirror row_mask:0xf bank_mask:0xf
  v_add_f32 v38, v38, v37
  v_mov_b32 v37, v38
  s_nop 1
  v_permlane16_swap_b32 v38, v37
  v_add_f32 v38, v38, v37
  v_mov_b32 v37, v38
  s_nop 1
  v_permlane32_swap_b32 v38, v37
  v_add_f32 v38, v38, v37
  v_mul_f32 v38, 0x3b000000, v38
  v_cvt_pk_bf16_f32 v37, v38, v38
  v_lshlrev_b32 v38, 16, v37
  v_add_f32 v38, 0x3727c5ac, v38
  v_cvt_pk_bf16_f32 v37, v38, v38
  v_lshlrev_b32 v38, 16, v37
  v_sqrt_f32 v38, v38
  s_nop 0
  v_cvt_pk_bf16_f32 v37, v38, v38
  v_lshlrev_b32 v38, 16, v37
  v_rcp_f32 v38, v38
  v_cvt_pk_bf16_f32 v37, v36, v36
  v_lshlrev_b32 v36, 16, v37
  v_sub_f32 v16, v16, v36
  v_cvt_pk_bf16_f32 v37, v16, v16
  v_lshlrev_b32 v16, 16, v37
  v_mul_f32 v16, v16, v38
  v_cvt_pk_bf16_f32 v37, v16, v16
  v_lshlrev_b32 v16, 16, v37
  v_sub_f32 v17, v17, v36
  v_cvt_pk_bf16_f32 v37, v17, v17
  v_lshlrev_b32 v17, 16, v37
  v_mul_f32 v17, v17, v38
  v_cvt_pk_bf16_f32 v37, v17, v17
  v_lshlrev_b32 v17, 16, v37
  v_sub_f32 v18, v18, v36
  v_cvt_pk_bf16_f32 v37, v18, v18
  v_lshlrev_b32 v18, 16, v37
  v_mul_f32 v18, v18, v38
  v_cvt_pk_bf16_f32 v37, v18, v18
  v_lshlrev_b32 v18, 16, v37
  v_sub_f32 v19, v19, v36
  v_cvt_pk_bf16_f32 v37, v19, v19
  v_lshlrev_b32 v19, 16, v37
  v_mul_f32 v19, v19, v38
  v_cvt_pk_bf16_f32 v37, v19, v19
  v_lshlrev_b32 v19, 16, v37
  v_sub_f32 v20, v20, v36
  v_cvt_pk_bf16_f32 v37, v20, v20
  v_lshlrev_b32 v20, 16, v37
  v_mul_f32 v20, v20, v38
  v_cvt_pk_bf16_f32 v37, v20, v20
  v_lshlrev_b32 v20, 16, v37
  v_sub_f32 v21, v21, v36
  v_cvt_pk_bf16_f32 v37, v21, v21
  v_lshlrev_b32 v21, 16, v37
  v_mul_f32 v21, v21, v38
  v_cvt_pk_bf16_f32 v37, v21, v21
  v_lshlrev_b32 v21, 16, v37
  v_sub_f32 v22, v22, v36
  v_cvt_pk_bf16_f32 v37, v22, v22
  v_lshlrev_b32 v22, 16, v37
  v_mul_f32 v22, v22, v38
  v_cvt_pk_bf16_f32 v37, v22, v22
  v_lshlrev_b32 v22, 16, v37
  v_sub_f32 v23, v23, v36
  v_cvt_pk_bf16_f32 v37, v23, v23
  v_lshlrev_b32 v23, 16, v37
  v_mul_f32 v23, v23, v38
  v_cvt_pk_bf16_f32 v37, v23, v23
  v_lshlrev_b32 v23, 16, v37
  v_cvt_pk_bf16_f32 v12, v16, v17
  v_cvt_pk_bf16_f32 v13, v18, v19
  v_cvt_pk_bf16_f32 v14, v20, v21
  v_cvt_pk_bf16_f32 v15, v22, v23
  ds_write_b128 v6, v[12:15] offset:0
  v_lshlrev_b32 v7, 4, v3
  s_waitcnt lgkmcnt(0)
  ds_read_b128 v[48:51], v7 offset:0
  ds_read_b128 v[52:55], v7 offset:64
  ds_read_b128 v[56:59], v7 offset:128
  ds_read_b128 v[60:63], v7 offset:192
  ds_read_b128 v[64:67], v7 offset:256
  ds_read_b128 v[68:71], v7 offset:320
  ds_read_b128 v[72:75], v7 offset:384
  ds_read_b128 v[76:79], v7 offset:448
  ds_read_b128 v[80:83], v7 offset:512
  ds_read_b128 v[84:87], v7 offset:576
  ds_read_b128 v[88:91], v7 offset:640
  ds_read_b128 v[92:95], v7 offset:704
  ds_read_b128 v[96:99], v7 offset:768
  ds_read_b128 v[100:103], v7 offset:832
  ds_read_b128 v[104:107], v7 offset:896
  ds_read_b128 v[108:111], v7 offset:960
  s_waitcnt vmcnt(0)
  s_barrier
  ds_read_b64_tr_b16 v[112:113], v208 offset:2048
  ds_read_b64_tr_b16 v[114:115], v208 offset:2304
  ds_read_b64_tr_b16 v[116:117], v208 offset:4096
  ds_read_b64_tr_b16 v[118:119], v208 offset:4352
  ds_read_b64_tr_b16 v[120:121], v208 offset:6144
  ds_read_b64_tr_b16 v[122:123], v208 offset:6400
  ds_read_b64_tr_b16 v[124:125], v208 offset:8192
  ds_read_b64_tr_b16 v[126:127], v208 offset:8448
  ds_read_b64_tr_b16 v[128:129], v208 offset:10240
  ds_read_b64_tr_b16 v[130:131], v208 offset:10496
  ds_read_b64_tr_b16 v[132:133], v208 offset:12288
  ds_read_b64_tr_b16 v[134:135], v208 offset:12544
  ds_read_b64_tr_b16 v[136:137], v208 offset:14336
  ds_read_b64_tr_b16 v[138:139], v208 offset:14592
  ds_read_b64_tr_b16 v[140:141], v208 offset:16384
  ds_read_b64_tr_b16 v[142:143], v208 offset:16640
  s_waitcnt lgkmcnt(0)
  v_mfma_f32_16x16x32_bf16 v[16:19], v[48:51], v[112:115], 0
  v_mfma_f32_16x16x32_bf16 v[16:19], v[52:55], v[116:119], v[16:19]
  v_mfma_f32_16x16x32_bf16 v[16:19], v[56:59], v[120:123], v[16:19]
  v_mfma_f32_16x16x32_bf16 v[16:19], v[60:63], v[124:127], v[16:19]
  v_mfma_f32_16x16x32_bf16 v[16:19], v[64:67], v[128:131], v[16:19]
  v_mfma_f32_16x16x32_bf16 v[16:19], v[68:71], v[132:135], v[16:19]
  v_mfma_f32_16x16x32_bf16 v[16:19], v[72:75], v[136:139], v[16:19]
  v_mfma_f32_16x16x32_bf16 v[16:19], v[76:79], v[140:143], v[16:19]
  ds_read_b64_tr_b16 v[112:113], v208 offset:18432
  ds_read_b64_tr_b16 v[114:115], v208 offset:18688
  ds_read_b64_tr_b16 v[116:117], v208 offset:20480
  ds_read_b64_tr_b16 v[118:119], v208 offset:20736
  ds_read_b64_tr_b16 v[120:121], v208 offset:22528
  ds_read_b64_tr_b16 v[122:123], v208 offset:22784
  ds_read_b64_tr_b16 v[124:125], v208 offset:24576
  ds_read_b64_tr_b16 v[126:127], v208 offset:24832
  ds_read_b64_tr_b16 v[128:129], v208 offset:26624
  ds_read_b64_tr_b16 v[130:131], v208 offset:26880
  ds_read_b64_tr_b16 v[132:133], v208 offset:28672
  ds_read_b64_tr_b16 v[134:135], v208 offset:28928
  ds_read_b64_tr_b16 v[136:137], v208 offset:30720
  ds_read_b64_tr_b16 v[138:139], v208 offset:30976
  ds_read_b64_tr_b16 v[140:141], v208 offset:32768
  ds_read_b64_tr_b16 v[142:143], v208 offset:33024
  s_waitcnt lgkmcnt(0)
  v_mfma_f32_16x16x32_bf16 v[16:19], v[80:83], v[112:115], v[16:19]
  v_mfma_f32_16x16x32_bf16 v[16:19], v[84:87], v[116:119], v[16:19]
  v_mfma_f32_16x16x32_bf16 v[16:19], v[88:91], v[120:123], v[16:19]
  v_mfma_f32_16x16x32_bf16 v[16:19], v[92:95], v[124:127], v[16:19]
  v_mfma_f32_16x16x32_bf16 v[16:19], v[96:99], v[128:131], v[16:19]
  v_mfma_f32_16x16x32_bf16 v[16:19], v[100:103], v[132:135], v[16:19]
  v_mfma_f32_16x16x32_bf16 v[16:19], v[104:107], v[136:139], v[16:19]
  v_mfma_f32_16x16x32_bf16 v[16:19], v[108:111], v[140:143], v[16:19]
  ds_read_b64_tr_b16 v[112:113], v208 offset:2080
  ds_read_b64_tr_b16 v[114:115], v208 offset:2336
  ds_read_b64_tr_b16 v[116:117], v208 offset:4128
  ds_read_b64_tr_b16 v[118:119], v208 offset:4384
  ds_read_b64_tr_b16 v[120:121], v208 offset:6176
  ds_read_b64_tr_b16 v[122:123], v208 offset:6432
  ds_read_b64_tr_b16 v[124:125], v208 offset:8224
  ds_read_b64_tr_b16 v[126:127], v208 offset:8480
  ds_read_b64_tr_b16 v[128:129], v208 offset:10272
  ds_read_b64_tr_b16 v[130:131], v208 offset:10528
  ds_read_b64_tr_b16 v[132:133], v208 offset:12320
  ds_read_b64_tr_b16 v[134:135], v208 offset:12576
  ds_read_b64_tr_b16 v[136:137], v208 offset:14368
  ds_read_b64_tr_b16 v[138:139], v208 offset:14624
  ds_read_b64_tr_b16 v[140:141], v208 offset:16416
  ds_read_b64_tr_b16 v[142:143], v208 offset:16672
  s_waitcnt lgkmcnt(0)
  v_mfma_f32_16x16x32_bf16 v[20:23], v[48:51], v[112:115], 0
  v_mfma_f32_16x16x32_bf16 v[20:23], v[52:55], v[116:119], v[20:23]
  v_mfma_f32_16x16x32_bf16 v[20:23], v[56:59], v[120:123], v[20:23]
  v_mfma_f32_16x16x32_bf16 v[20:23], v[60:63], v[124:127], v[20:23]
  v_mfma_f32_16x16x32_bf16 v[20:23], v[64:67], v[128:131], v[20:23]
  v_mfma_f32_16x16x32_bf16 v[20:23], v[68:71], v[132:135], v[20:23]
  v_mfma_f32_16x16x32_bf16 v[20:23], v[72:75], v[136:139], v[20:23]
  v_mfma_f32_16x16x32_bf16 v[20:23], v[76:79], v[140:143], v[20:23]
  ds_read_b64_tr_b16 v[112:113], v208 offset:18464
  ds_read_b64_tr_b16 v[114:115], v208 offset:18720
  ds_read_b64_tr_b16 v[116:117], v208 offset:20512
  ds_read_b64_tr_b16 v[118:119], v208 offset:20768
  ds_read_b64_tr_b16 v[120:121], v208 offset:22560
  ds_read_b64_tr_b16 v[122:123], v208 offset:22816
  ds_read_b64_tr_b16 v[124:125], v208 offset:24608
  ds_read_b64_tr_b16 v[126:127], v208 offset:24864
  ds_read_b64_tr_b16 v[128:129], v208 offset:26656
  ds_read_b64_tr_b16 v[130:131], v208 offset:26912
  ds_read_b64_tr_b16 v[132:133], v208 offset:28704
  ds_read_b64_tr_b16 v[134:135], v208 offset:28960
  ds_read_b64_tr_b16 v[136:137], v208 offset:30752
  ds_read_b64_tr_b16 v[138:139], v208 offset:31008
  ds_read_b64_tr_b16 v[140:141], v208 offset:32800
  ds_read_b64_tr_b16 v[142:143], v208 offset:33056
  s_waitcnt lgkmcnt(0)
  v_mfma_f32_16x16x32_bf16 v[20:23], v[80:83], v[112:115], v[20:23]
  v_mfma_f32_16x16x32_bf16 v[20:23], v[84:87], v[116:119], v[20:23]
  v_mfma_f32_16x16x32_bf16 v[20:23], v[88:91], v[120:123], v[20:23]
  v_mfma_f32_16x16x32_bf16 v[20:23], v[92:95], v[124:127], v[20:23]
  v_mfma_f32_16x16x32_bf16 v[20:23], v[96:99], v[128:131], v[20:23]
  v_mfma_f32_16x16x32_bf16 v[20:23], v[100:103], v[132:135], v[20:23]
  v_mfma_f32_16x16x32_bf16 v[20:23], v[104:107], v[136:139], v[20:23]
  v_mfma_f32_16x16x32_bf16 v[20:23], v[108:111], v[140:143], v[20:23]
  v_and_b32 v36, 1, v3
  v_cmp_eq_u32 vcc, 1, v36
  s_nop 7
  v_cndmask_b32 v16, v16, v20, vcc
  v_cvt_pk_bf16_f32 v36, v16, v16
  v_lshlrev_b32 v16, 16, v36
  v_lshlrev_b32 v10, 16, v10
  v_add_f32 v16, v16, v10
  v_cvt_pk_bf16_f32 v36, v16, v16
  v_lshlrev_b32 v16, 16, v36
  v_max_f32 v16, 0, v16
  v_mul_f32 v16, v16, v16
  v_cvt_pk_bf16_f32 v16, v16, v16
  v_and_b32 v36, 31, v1
  v_lshlrev_b32 v36, 1, v36
  ds_write_b16 v36, v16 offset:1024
  s_waitcnt lgkmcnt(0)
  ds_read_b128 v[44:47], v7 offset:1024
  ds_read_b64_tr_b16 v[112:113], v210 offset:0
  ds_read_b64_tr_b16 v[114:115], v210 offset:4224
  ds_read_b64_tr_b16 v[116:117], v210 offset:32
  ds_read_b64_tr_b16 v[118:119], v210 offset:4256
  ds_read_b64_tr_b16 v[120:121], v210 offset:64
  ds_read_b64_tr_b16 v[122:123], v210 offset:4288
  ds_read_b64_tr_b16 v[124:125], v210 offset:96
  ds_read_b64_tr_b16 v[126:127], v210 offset:4320
  ds_read_b64_tr_b16 v[128:129], v210 offset:128
  ds_read_b64_tr_b16 v[130:131], v210 offset:4352
  ds_read_b64_tr_b16 v[132:133], v210 offset:160
  ds_read_b64_tr_b16 v[134:135], v210 offset:4384
  ds_read_b64_tr_b16 v[136:137], v210 offset:192
  ds_read_b64_tr_b16 v[138:139], v210 offset:4416
  ds_read_b64_tr_b16 v[140:141], v210 offset:224
  ds_read_b64_tr_b16 v[142:143], v210 offset:4448
  s_waitcnt lgkmcnt(0)
  v_mfma_f32_16x16x32_bf16 v[48:51], v[44:47], v[112:115], 0
  v_mfma_f32_16x16x32_bf16 v[52:55], v[44:47], v[116:119], 0
  v_mfma_f32_16x16x32_bf16 v[56:59], v[44:47], v[120:123], 0
  v_mfma_f32_16x16x32_bf16 v[60:63], v[44:47], v[124:127], 0
  v_mfma_f32_16x16x32_bf16 v[64:67], v[44:47], v[128:131], 0
  v_mfma_f32_16x16x32_bf16 v[68:71], v[44:47], v[132:135], 0
  v_mfma_f32_16x16x32_bf16 v[72:75], v[44:47], v[136:139], 0
  v_mfma_f32_16x16x32_bf16 v[76:79], v[44:47], v[140:143], 0
  ds_read_b64_tr_b16 v[112:113], v210 offset:256
  ds_read_b64_tr_b16 v[114:115], v210 offset:4480
  ds_read_b64_tr_b16 v[116:117], v210 offset:288
  ds_read_b64_tr_b16 v[118:119], v210 offset:4512
  ds_read_b64_tr_b16 v[120:121], v210 offset:320
  ds_read_b64_tr_b16 v[122:123], v210 offset:4544
  ds_read_b64_tr_b16 v[124:125], v210 offset:352
  ds_read_b64_tr_b16 v[126:127], v210 offset:4576
  ds_read_b64_tr_b16 v[128:129], v210 offset:384
  ds_read_b64_tr_b16 v[130:131], v210 offset:4608
  ds_read_b64_tr_b16 v[132:133], v210 offset:416
  ds_read_b64_tr_b16 v[134:135], v210 offset:4640
  ds_read_b64_tr_b16 v[136:137], v210 offset:448
  ds_read_b64_tr_b16 v[138:139], v210 offset:4672
  ds_read_b64_tr_b16 v[140:141], v210 offset:480
  ds_read_b64_tr_b16 v[142:143], v210 offset:4704
  s_waitcnt lgkmcnt(0)
  v_mfma_f32_16x16x32_bf16 v[80:83], v[44:47], v[112:115], 0
  v_mfma_f32_16x16x32_bf16 v[84:87], v[44:47], v[116:119], 0
  v_mfma_f32_16x16x32_bf16 v[88:91], v[44:47], v[120:123], 0
  v_mfma_f32_16x16x32_bf16 v[92:95], v[44:47], v[124:127], 0
  v_mfma_f32_16x16x32_bf16 v[96:99], v[44:47], v[128:131], 0
  v_mfma_f32_16x16x32_bf16 v[100:103], v[44:47], v[132:135], 0
  v_mfma_f32_16x16x32_bf16 v[104:107], v[44:47], v[136:139], 0
  v_mfma_f32_16x16x32_bf16 v[108:111], v[44:47], v[140:143], 0
  ds_read_b64_tr_b16 v[112:113], v210 offset:512
  ds_read_b64_tr_b16 v[114:115], v210 offset:4736
  ds_read_b64_tr_b16 v[116:117], v210 offset:544
  ds_read_b64_tr_b16 v[118:119], v210 offset:4768
  ds_read_b64_tr_b16 v[120:121], v210 offset:576
  ds_read_b64_tr_b16 v[122:123], v210 offset:4800
  ds_read_b64_tr_b16 v[124:125], v210 offset:608
  ds_read_b64_tr_b16 v[126:127], v210 offset:4832
  ds_read_b64_tr_b16 v[128:129], v210 offset:640
  ds_read_b64_tr_b16 v[130:131], v210 offset:4864
  ds_read_b64_tr_b16 v[132:133], v210 offset:672
  ds_read_b64_tr_b16 v[134:135], v210 offset:4896
  ds_read_b64_tr_b16 v[136:137], v210 offset:704
  ds_read_b64_tr_b16 v[138:139], v210 offset:4928
  ds_read_b64_tr_b16 v[140:141], v210 offset:736
  ds_read_b64_tr_b16 v[142:143], v210 offset:4960
  s_waitcnt lgkmcnt(0)
  v_mfma_f32_16x16x32_bf16 v[144:147], v[44:47], v[112:115], 0
  v_mfma_f32_16x16x32_bf16 v[148:151], v[44:47], v[116:119], 0
  v_mfma_f32_16x16x32_bf16 v[152:155], v[44:47], v[120:123], 0
  v_mfma_f32_16x16x32_bf16 v[156:159], v[44:47], v[124:127], 0
  v_mfma_f32_16x16x32_bf16 v[160:163], v[44:47], v[128:131], 0
  v_mfma_f32_16x16x32_bf16 v[164:167], v[44:47], v[132:135], 0
  v_mfma_f32_16x16x32_bf16 v[168:171], v[44:47], v[136:139], 0
  v_mfma_f32_16x16x32_bf16 v[172:175], v[44:47], v[140:143], 0
  ds_read_b64_tr_b16 v[112:113], v210 offset:768
  ds_read_b64_tr_b16 v[114:115], v210 offset:4992
  ds_read_b64_tr_b16 v[116:117], v210 offset:800
  ds_read_b64_tr_b16 v[118:119], v210 offset:5024
  ds_read_b64_tr_b16 v[120:121], v210 offset:832
  ds_read_b64_tr_b16 v[122:123], v210 offset:5056
  ds_read_b64_tr_b16 v[124:125], v210 offset:864
  ds_read_b64_tr_b16 v[126:127], v210 offset:5088
  ds_read_b64_tr_b16 v[128:129], v210 offset:896
  ds_read_b64_tr_b16 v[130:131], v210 offset:5120
  ds_read_b64_tr_b16 v[132:133], v210 offset:928
  ds_read_b64_tr_b16 v[134:135], v210 offset:5152
  ds_read_b64_tr_b16 v[136:137], v210 offset:960
  ds_read_b64_tr_b16 v[138:139], v210 offset:5184
  ds_read_b64_tr_b16 v[140:141], v210 offset:992
  ds_read_b64_tr_b16 v[142:143], v210 offset:5216
  s_waitcnt lgkmcnt(0)
  v_mfma_f32_16x16x32_bf16 v[176:179], v[44:47], v[112:115], 0
  v_mfma_f32_16x16x32_bf16 v[180:183], v[44:47], v[116:119], 0
  v_mfma_f32_16x16x32_bf16 v[184:187], v[44:47], v[120:123], 0
  v_mfma_f32_16x16x32_bf16 v[188:191], v[44:47], v[124:127], 0
  v_mfma_f32_16x16x32_bf16 v[192:195], v[44:47], v[128:131], 0
  v_mfma_f32_16x16x32_bf16 v[196:199], v[44:47], v[132:135], 0
  v_mfma_f32_16x16x32_bf16 v[200:203], v[44:47], v[136:139], 0
  v_mfma_f32_16x16x32_bf16 v[204:207], v[44:47], v[140:143], 0
  v_cmp_eq_u32 s[26:27], 1, v3
  v_cmp_eq_u32 s[28:29], 2, v3
  v_cmp_eq_u32 s[30:31], 3, v3
  v_lshlrev_b32 v36, 2, v1
  v_add_u32 v36, 10240, v36
  s_nop 7
  v_cndmask_b32 v48, v48, v52, s[26:27]
  v_cndmask_b32 v48, v48, v56, s[28:29]
  v_cndmask_b32 v48, v48, v60, s[30:31]
  global_atomic_add_f32 v36, v48, s[8:9] offset:0
  v_cndmask_b32 v64, v64, v68, s[26:27]
  v_cndmask_b32 v64, v64, v72, s[28:29]
  v_cndmask_b32 v64, v64, v76, s[30:31]
  global_atomic_add_f32 v36, v64, s[8:9] offset:256
  v_cndmask_b32 v80, v80, v84, s[26:27]
  v_cndmask_b32 v80, v80, v88, s[28:29]
  v_cndmask_b32 v80, v80, v92, s[30:31]
  global_atomic_add_f32 v36, v80, s[8:9] offset:512
  v_cndmask_b32 v96, v96, v100, s[26:27]
  v_cndmask_b32 v96, v96, v104, s[28:29]
  v_cndmask_b32 v96, v96, v108, s[30:31]
  global_atomic_add_f32 v36, v96, s[8:9] offset:768
  v_cndmask_b32 v144, v144, v148, s[26:27]
  v_cndmask_b32 v144, v144, v152, s[28:29]
  v_cndmask_b32 v144, v144, v156, s[30:31]
  global_atomic_add_f32 v36, v144, s[8:9] offset:1024
  v_cndmask_b32 v160, v160, v164, s[26:27]
  v_cndmask_b32 v160, v160, v168, s[28:29]
  v_cndmask_b32 v160, v160, v172, s[30:31]
  global_atomic_add_f32 v36, v160, s[8:9] offset:1280
  v_cndmask_b32 v176, v176, v180, s[26:27]
  v_cndmask_b32 v176, v176, v184, s[28:29]
  v_cndmask_b32 v176, v176, v188, s[30:31]
  global_atomic_add_f32 v36, v176, s[8:9] offset:1536
  v_cndmask_b32 v192, v192, v196, s[26:27]
  v_cndmask_b32 v192, v192, v200, s[28:29]
  v_cndmask_b32 v192, v192, v204, s[30:31]
  global_atomic_add_f32 v36, v192, s[8:9] offset:1792
  s_waitcnt vmcnt(0)
  v_mov_b32 v38, 0
  v_mov_b32 v39, 1
  v_cmp_eq_u32 vcc, 0, v1
  s_and_saveexec_b64 s[24:25], vcc
  global_atomic_add v38, v38, v39, s[18:19] sc0
  s_waitcnt vmcnt(0)
  s_mov_b64 exec, s[24:25]
  v_readfirstlane_b32 s26, v38
  s_cmp_lg_u32 s26, 55
  s_cbranch_scc1 L_m_end
  v_lshlrev_b32 v36, 5, v1
  v_add_u32 v36, 10240, v36
  v_mov_b32 v39, 0
  global_atomic_add_f32 v112, v36, v39, s[8:9] offset:0 sc0
  global_atomic_add_f32 v113, v36, v39, s[8:9] offset:4 sc0
  global_atomic_add_f32 v114, v36, v39, s[8:9] offset:8 sc0
  global_atomic_add_f32 v115, v36, v39, s[8:9] offset:12 sc0
  global_atomic_add_f32 v116, v36, v39, s[8:9] offset:16 sc0
  global_atomic_add_f32 v117, v36, v39, s[8:9] offset:20 sc0
  global_atomic_add_f32 v118, v36, v39, s[8:9] offset:24 sc0
  global_atomic_add_f32 v119, v36, v39, s[8:9] offset:28 sc0
  v_lshlrev_b32 v48, 16, v40
  v_and_b32 v49, 0xffff0000, v40
  v_lshlrev_b32 v50, 16, v41
  v_and_b32 v51, 0xffff0000, v41
  v_lshlrev_b32 v52, 16, v42
  v_and_b32 v53, 0xffff0000, v42
  v_lshlrev_b32 v54, 16, v43
  v_and_b32 v55, 0xffff0000, v43
  s_waitcnt vmcnt(0)
  v_cvt_pk_bf16_f32 v36, v112, v112
  v_lshlrev_b32 v112, 16, v36
  v_add_f32 v112, v112, v48
  v_cvt_pk_bf16_f32 v36, v112, v112
  v_lshlrev_b32 v112, 16, v36
  v_add_f32 v112, v112, v24
  v_cvt_pk_bf16_f32 v36, v113, v113
  v_lshlrev_b32 v113, 16, v36
  v_add_f32 v113, v113, v49
  v_cvt_pk_bf16_f32 v36, v113, v113
  v_lshlrev_b32 v113, 16, v36
  v_add_f32 v113, v113, v25
  v_cvt_pk_bf16_f32 v36, v114, v114
  v_lshlrev_b32 v114, 16, v36
  v_add_f32 v114, v114, v50
  v_cvt_pk_bf16_f32 v36, v114, v114
  v_lshlrev_b32 v114, 16, v36
  v_add_f32 v114, v114, v26
  v_cvt_pk_bf16_f32 v36, v115, v115
  v_lshlrev_b32 v115, 16, v36
  v_add_f32 v115, v115, v51
  v_cvt_pk_bf16_f32 v36, v115, v115
  v_lshlrev_b32 v115, 16, v36
  v_add_f32 v115, v115, v27
  v_cvt_pk_bf16_f32 v36, v116, v116
  v_lshlrev_b32 v116, 16, v36
  v_add_f32 v116, v116, v52
  v_cvt_pk_bf16_f32 v36, v116, v116
  v_lshlrev_b32 v116, 16, v36
  v_add_f32 v116, v116, v28
  v_cvt_pk_bf16_f32 v36, v117, v117
  v_lshlrev_b32 v117, 16, v36
  v_add_f32 v117, v117, v53
  v_cvt_pk_bf16_f32 v36, v117, v117
  v_lshlrev_b32 v117, 16, v36
  v_add_f32 v117, v117, v29
  v_cvt_pk_bf16_f32 v36, v118, v118
  v_lshlrev_b32 v118, 16, v36
  v_add_f32 v118, v118, v54
  v_cvt_pk_bf16_f32 v36, v118, v118
  v_lshlrev_b32 v118, 16, v36
  v_add_f32 v118, v118, v30
  v_cvt_pk_bf16_f32 v36, v119, v119
  v_lshlrev_b32 v119, 16, v36
  v_add_f32 v119, v119, v55
  v_cvt_pk_bf16_f32 v36, v119, v119
  v_lshlrev_b32 v119, 16, v36
  v_add_f32 v119, v119, v31
  v_cvt_pk_bf16_f32 v12, v112, v113
  v_cvt_pk_bf16_f32 v13, v114, v115
  v_cvt_pk_bf16_f32 v14, v116, v117
  v_cvt_pk_bf16_f32 v15, v118, v119
  global_store_dwordx4 v6, v[12:15], s[16:17]
L_m_end:
  s_endpgm
.section .rodata,"a"
.p2align 6
.amdhsa_kernel mlp_kernel
  .amdhsa_next_free_vgpr 216
  .amdhsa_next_free_sgpr 96
  .amdhsa_accum_offset 216
  .amdhsa_group_segment_fixed_size 0
  .amdhsa_kernarg_size 104
  .amdhsa_user_sgpr_count 2
  .amdhsa_user_sgpr_kernarg_segment_ptr 1
  .amdhsa_system_sgpr_workgroup_id_x 1
.end_amdhsa_kernel
.text
```
